```python
import torch

def _softmax(x, axis=-1):
    return torch.softmax(x, dim=axis)
def _gelu(x):
    return torch.nn.functional.gelu(x, approximate="tanh")
def _silu(x):
    return torch.nn.functional.silu(x)
def _sigmoid(x):
    return torch.sigmoid(x)
def _layernorm(x, axis=-1, eps=1e-5):
    m = x.mean(dim=axis, keepdim=True)
    v = x.var(dim=axis, keepdim=True, unbiased=False)
    return (x - m) / torch.sqrt(v + eps)
def _scatter_add(tgt, idx, src, axis=0):
    return tgt.clone().index_add_(axis, idx, src)
def _segment_sum(src, seg, n):
    out = torch.zeros((n,) + src.shape[1:], dtype=src.dtype)
    return out.index_add_(0, seg, src)
def _pad(x, pw):
    flat = tuple(v for pair in reversed(pw) for v in pair)
    return torch.nn.functional.pad(x, flat)

kernel_name = 'recurrent_scan__compressed_kv_cla__dense_activation_gelu__decode'

def setup_inputs():

    _w = (lambda a: (lambda t: t.to(torch.bfloat16) if t.is_floating_point() else t)(torch.as_tensor(a)))
    def _A_setup():
        B, H, Sq, Sk, D, M = 1, 32, 1, 16384, 128, 576
        Dc = 4 * D
        return {
            "x": _w((lambda *s: torch.randn(*s, dtype=torch.bfloat16) * 0.1)(B, Sq, M)),
            "c_kv": _w((lambda *s: torch.randn(*s, dtype=torch.bfloat16) * 3.2)(B, Sk, Dc)),
            "w_q": _w((lambda *s: torch.randn(*s, dtype=torch.bfloat16) * 0.8)(M, H, D) * (M ** -0.5)),
            "w_uk": _w((lambda *s: torch.randn(*s, dtype=torch.bfloat16) * 0.8)(Dc, H, D) * (Dc ** -0.5)),
            "w_uv": _w((lambda *s: torch.randn(*s, dtype=torch.bfloat16) * 3.2)(Dc, H, D) * (Dc ** -0.5)),
            "w_o": _w((lambda *s: torch.randn(*s, dtype=torch.bfloat16) * 3.2)(H, D, M) * ((H * D) ** -0.5)),
        }
    _A_in = _A_setup()

    def _B_setup():
        B, S, D, F = 1, 1, 576, 4608
        return {
            "x": _w((lambda *s: torch.randn(*s, dtype=torch.bfloat16) * 0.1)(B, S, D)),
            "w1": _w((lambda *s: torch.randn(*s, dtype=torch.bfloat16) * 3.2)(D, F) * (D ** -0.5)),
            "b1": _w((lambda *s: torch.randn(*s, dtype=torch.bfloat16) * 3.2)(F) * 0.01),
            "w2": _w((lambda *s: torch.randn(*s, dtype=torch.bfloat16) * 0.8)(F, D) * (F ** -0.5)),
            "b2": _w((lambda *s: torch.randn(*s, dtype=torch.bfloat16) * 0.8)(D) * 0.01),
        }
    _B_in = _B_setup()

    return {
        "A_x": _A_in["x"],
        "A_c_kv": _A_in["c_kv"],
        "A_w_q": _A_in["w_q"],
        "A_w_uk": _A_in["w_uk"],
        "A_w_uv": _A_in["w_uv"],
        "A_w_o": _A_in["w_o"],
        "B_x": _B_in["x"],
        "B_w1": _B_in["w1"],
        "B_b1": _B_in["b1"],
        "B_w2": _B_in["w2"],
        "B_b2": _B_in["b2"],
    }

def reference(A_x, A_c_kv, A_w_q, A_w_uk, A_w_uv, A_w_o, B_x, B_w1, B_b1, B_w2, B_b2):
    def _A_ref(x, c_kv, w_q, w_uk, w_uv, w_o):
        B, Sq, M = x.shape[0], x.shape[1], x.shape[2]
        Sk = c_kv.shape[1]
        H, D = w_q.shape[1], w_q.shape[2]
        q = torch.einsum("bqm,mhd->bhqd", x, w_q)
        k = torch.einsum("bkc,chd->bhkd", c_kv, w_uk)
        v = torch.einsum("bkc,chd->bhkd", c_kv, w_uv)
        scores = torch.einsum("bhqd,bhkd->bhqk", q, k) * (D ** -0.5)
        off = Sk - Sq
        qi = torch.arange(Sq)[:, None]
        kj = torch.arange(Sk)[None, :]
        cmask = kj <= (qi + off)
        scores = torch.where(cmask[None, None], scores, -1e9)
        p = _softmax(scores, axis=-1)
        ctx = torch.einsum("bhqk,bhkd->bhqd", p, v)
        return torch.einsum("bhqd,hdm->bqm", ctx, w_o)

    def _B_ref(x, w1, b1, w2, b2):
        h = torch.einsum("bsd,df->bsf", x, w1) + b1
        h = _gelu(h)
        return torch.einsum("bsf,fd->bsd", h, w2) + b2

    x = A_x
    xn = _layernorm(x, axis=-1)
    s = _A_ref(xn, A_c_kv, A_w_q, A_w_uk, A_w_uv, A_w_o)
    g = _silu(_B_ref(xn, B_w1, B_b1, B_w2, B_b2))
    return x + s * g
```

```asm
; @launch grid=(256,1,1) block=(512,1,1) lds=163712
.amdgcn_target "amdgcn-amd-amdhsa--gfx950"
.text
.globl recurrent_scan__compressed_kv_cla__dense_activation_gelu__decode_kernel
.p2align 8
.type recurrent_scan__compressed_kv_cla__dense_activation_gelu__decode_kernel,@function
recurrent_scan__compressed_kv_cla__dense_activation_gelu__decode_kernel:
L_code_begin:
    s_cmp_ge_u32 s2, 256
    s_cbranch_scc1 L_end
    s_load_dwordx2 s[8:9], s[0:1], 0
    s_load_dwordx2 s[16:17], s[0:1], 16
    s_load_dwordx2 s[44:45], s[0:1], 8
    s_load_dwordx2 s[20:21], s[0:1], 24
    s_load_dwordx2 s[12:13], s[0:1], 104
    s_getpc_b64 s[60:61]
L_pc:
    s_sub_u32 s60, s60, L_pc-L_code_begin
    s_subb_u32 s61, s61, 0
    s_mov_b32 s62, L_code_end-L_code_begin
    s_mov_b32 s63, 0x20000
    s_bfe_u32 s68, s2, 0x10003
    s_lshl_b32 s68, s68, 13
    v_lshl_add_u32 v1, v0, 4, s68
    buffer_load_dwordx4 v[252:255], v1, s[60:63], 0 offen
    v_lshrrev_b32 v1, 6, v0
    v_and_b32 v0, 63, v0
    v_readfirstlane_b32 s3, v1
    s_mov_b32 s10, 1152
    s_mov_b32 s11, 0x20000
    s_mov_b32 s18, 4718592
    s_mov_b32 s19, 0x20000
    s_mov_b32 s46, 16777216
    s_mov_b32 s47, 0x20000
    s_mov_b32 s22, 4194304
    s_mov_b32 s23, 0x20000
    s_mov_b32 s14, 7340032
    s_mov_b32 s15, 0x20000
    s_and_b32 s4, s2, 7
    s_lshr_b32 s5, s2, 3
    s_lshr_b32 s64, s5, 4
    s_and_b32 s7, s5, 3
    s_and_b32 s6, s4, 3
    s_lshl_b32 s6, s6, 1
    s_bfe_u32 s69, s5, 0x10002
    s_add_u32 s6, s6, s69
    s_lshl_b32 s6, s6, 1
    s_lshr_b32 s69, s4, 2
    s_add_u32 s6, s6, s69
    s_lshl_b32 s6, s6, 1
    s_bfe_u32 s69, s5, 0x10003
    s_add_u32 s6, s6, s69
    s_and_b32 s77, s3, 3
    s_lshr_b32 s58, s3, 2
    s_lshl_b32 s65, s4, 4
    s_and_b32 s68, s5, 15
    s_add_u32 s65, s65, s68
    s_lshl_b32 s69, s6, 8
    v_lshrrev_b32 v1, 3, v0
    v_and_b32 v2, 7, v0
    v_lshlrev_b32 v3, 4, v0
    s_cmp_lt_u32 s3, 4
    s_cbranch_scc1 L_G0
    v_lshlrev_b32 v42, 2, v0
    v_lshlrev_b32 v14, 13, v1
    v_lshl_add_u32 v14, v2, 4, v14
    s_lshl_b32 s75, s64, 2
    s_add_u32 s75, s75, s7
    s_mul_i32 s66, s75, 9
    s_lshr_b32 s71, s77, 1
    s_mul_i32 s68, s71, 5
    s_add_u32 s66, s66, s68
    s_lshl_b32 s68, s66, 16
    s_add_u32 s68, s68, s69
    s_and_b32 s70, s77, 1
    s_lshl_b32 s70, s70, 7
    s_add_u32 s68, s68, s70
    s_add_u32 s70, s68, 262144
    s_setprio 3
    s_waitcnt lgkmcnt(0)
    buffer_load_dwordx4 v[80:83], v3, s[8:11], 0 offen
    buffer_load_dword v84, v42, s[8:11], 0 offen offset:1024
    buffer_load_dword v31, off, s[12:15], 0 sc1
    s_cmp_lg_u32 s71, 0
    s_cbranch_scc1 L_nx_1
    buffer_load_dwordx4 v[120:123], v14, s[16:19], s70 offen
L_nx_1:
    buffer_load_dwordx4 v[104:107], v14, s[16:19], s68 offen
    s_add_u32 s68, s68, 65536
    buffer_load_dwordx4 v[108:111], v14, s[16:19], s68 offen
    s_add_u32 s68, s68, 65536
    buffer_load_dwordx4 v[112:115], v14, s[16:19], s68 offen
    s_add_u32 s68, s68, 65536
    buffer_load_dwordx4 v[116:119], v14, s[16:19], s68 offen
    s_barrier
    s_branch L_S2
L_G0:
    v_and_b32 v12, 15, v0
    v_lshlrev_b32 v12, 2, v12
    v_add_u32 v12, 163648, v12
    v_mov_b32 v16, 0
    ds_write_b32 v12, v16
    v_bfrev_b32 v16, 1
    v_add_u32 v12, -1344, v12
    ds_write_b32 v12, v16
    s_lshl_b32 s70, s65, 2
    s_add_u32 s70, s70, s77
    s_lshl_b32 s70, s70, 15
    s_mul_i32 s71, s77, 33792
    v_lshlrev_b32 v14, 13, v2
    v_lshrrev_b32 v15, 4, v0
    v_lshl_add_u32 v14, v15, 4, v14
    v_and_b32 v13, 8, v0
    v_lshl_add_u32 v14, v13, 3, v14
    s_lshl_b32 s74, s7, 2
    s_add_u32 s74, s74, s77
    s_lshl_b32 s74, s74, 18
    s_add_u32 s74, s74, s69
    s_mov_b32 m0, s71
    s_cmp_lg_u32 s64, 0
    s_waitcnt lgkmcnt(0)
    buffer_load_dword v31, off, s[12:15], 0 sc1
    s_barrier
    s_cbranch_scc0 L_gy0_4
    buffer_load_dwordx4 v3, s[44:47], s70 offen lds
    s_branch L_GY1
L_gy0_4:
    buffer_load_dwordx4 v[80:83], v14, s[20:23], s74 offen offset:0
    buffer_load_dwordx4 v[84:87], v14, s[20:23], s74 offen offset:128
    s_add_u32 s74, s74, 65536
    buffer_load_dwordx4 v[88:91], v14, s[20:23], s74 offen offset:0
    buffer_load_dwordx4 v[92:95], v14, s[20:23], s74 offen offset:128
    s_add_u32 s74, s74, 65536
    buffer_load_dwordx4 v[96:99], v14, s[20:23], s74 offen offset:0
    buffer_load_dwordx4 v[100:103], v14, s[20:23], s74 offen offset:128
    s_add_u32 s74, s74, 65536
    buffer_load_dwordx4 v[104:107], v14, s[20:23], s74 offen offset:0
    buffer_load_dwordx4 v[108:111], v14, s[20:23], s74 offen offset:128
    s_branch L_GX1
L_S2:
    s_mov_b32 s26, 4194304
    s_mov_b32 s27, 0x20000
    s_mov_b32 s30, 4718592
    s_mov_b32 s31, 0x20000
    s_mov_b32 s34, 5308416
    s_mov_b32 s35, 0x20000
    s_mov_b32 s38, 5308416
    s_mov_b32 s39, 0x20000
    s_mov_b32 s42, 9216
    s_mov_b32 s43, 0x20000
    s_mov_b32 s50, 1152
    s_mov_b32 s51, 0x20000
    s_mov_b32 s54, 1152
    s_mov_b32 s55, 0x20000
    v_mov_b32 v40, 0
    v_and_b32 v12, 1, v0
    v_mov_b32 v13, 0xffff
    v_lshlrev_b32 v12, 4, v12
    v_lshlrev_b32 v12, v12, v13
    v_bfe_u32 v13, v0, 1, 2
    v_cmp_eq_u32 vcc, 0, v13
    s_nop 1
    v_cndmask_b32 v4, 0, v12, vcc
    v_cmp_eq_u32 vcc, 1, v13
    s_nop 1
    v_cndmask_b32 v5, 0, v12, vcc
    v_cmp_eq_u32 vcc, 2, v13
    s_nop 1
    v_cndmask_b32 v6, 0, v12, vcc
    v_cmp_eq_u32 vcc, 3, v13
    s_nop 1
    v_cndmask_b32 v7, 0, v12, vcc
    v_mov_b32 v8, 163648
    v_mov_b32 v9, 1
    v_mov_b32 v43, 0xff
    v_lshrrev_b32 v11, 5, v0
    v_bfe_u32 v12, v0, 4, 1
    v_lshlrev_b32 v12, 4, v12
    v_lshl_add_u32 v10, v2, 5, v12
    s_lshl_b32 s59, s6, 2
    s_add_u32 s59, s59, s7
    s_cmp_lg_u32 s71, 0
    s_cbranch_scc1 L_x1_2
    s_waitcnt vmcnt(5)
    s_branch L_x2_3
L_x1_2:
    s_waitcnt vmcnt(4)
L_x2_3:
    v_lshlrev_b32 v86, 16, v80
    v_and_b32 v87, 0xffff0000, v80
    v_lshlrev_b32 v88, 16, v81
    v_and_b32 v89, 0xffff0000, v81
    v_lshlrev_b32 v90, 16, v82
    v_and_b32 v91, 0xffff0000, v82
    v_lshlrev_b32 v92, 16, v83
    v_and_b32 v93, 0xffff0000, v83
    v_lshlrev_b32 v94, 16, v84
    v_and_b32 v95, 0xffff0000, v84
    v_add_f32 v12, v86, v87
    v_add_f32 v13, v88, v89
    v_add_f32 v12, v12, v90
    v_add_f32 v13, v13, v91
    v_add_f32 v12, v12, v92
    v_add_f32 v13, v13, v93
    v_add_f32 v12, v12, v94
    v_add_f32 v13, v13, v95
    v_add_f32 v12, v12, v13
    s_nop 1
    v_add_f32_dpp v12, v12, v12 row_ror:8 row_mask:0xf bank_mask:0xf
    s_nop 1
    v_add_f32_dpp v12, v12, v12 row_ror:4 row_mask:0xf bank_mask:0xf
    s_nop 1
    v_add_f32_dpp v12, v12, v12 row_ror:2 row_mask:0xf bank_mask:0xf
    s_nop 1
    v_add_f32_dpp v12, v12, v12 row_ror:1 row_mask:0xf bank_mask:0xf
    v_mov_b32 v13, v12
    s_nop 1
    v_permlane16_swap_b32 v12, v13
    v_add_f32 v12, v12, v13
    v_mov_b32 v13, v12
    s_nop 1
    v_permlane32_swap_b32 v12, v13
    v_add_f32 v12, v12, v13
    v_mul_f32 v12, 0x3ae38e39, v12
    v_cmp_gt_u32 vcc, 32, v0
    v_sub_f32 v15, v86, v12
    v_mul_f32 v14, v15, v15
    v_sub_f32 v15, v87, v12
    v_fmac_f32 v14, v15, v15
    v_sub_f32 v15, v88, v12
    v_fmac_f32 v14, v15, v15
    v_sub_f32 v15, v89, v12
    v_fmac_f32 v14, v15, v15
    v_sub_f32 v15, v90, v12
    v_fmac_f32 v14, v15, v15
    v_sub_f32 v15, v91, v12
    v_fmac_f32 v14, v15, v15
    v_sub_f32 v15, v92, v12
    v_fmac_f32 v14, v15, v15
    v_sub_f32 v15, v93, v12
    v_fmac_f32 v14, v15, v15
    v_sub_f32 v15, v94, v12
    v_cndmask_b32 v15, 0, v15, vcc
    v_fmac_f32 v14, v15, v15
    v_sub_f32 v15, v95, v12
    v_cndmask_b32 v15, 0, v15, vcc
    v_fmac_f32 v14, v15, v15
    s_nop 1
    v_add_f32_dpp v14, v14, v14 row_ror:8 row_mask:0xf bank_mask:0xf
    s_nop 1
    v_add_f32_dpp v14, v14, v14 row_ror:4 row_mask:0xf bank_mask:0xf
    s_nop 1
    v_add_f32_dpp v14, v14, v14 row_ror:2 row_mask:0xf bank_mask:0xf
    s_nop 1
    v_add_f32_dpp v14, v14, v14 row_ror:1 row_mask:0xf bank_mask:0xf
    v_mov_b32 v13, v14
    s_nop 1
    v_permlane16_swap_b32 v14, v13
    v_add_f32 v14, v14, v13
    v_mov_b32 v13, v14
    s_nop 1
    v_permlane32_swap_b32 v14, v13
    v_add_f32 v14, v14, v13
    v_mul_f32 v14, 0x3ae38e39, v14
    v_cvt_pk_bf16_f32 v14, v14, v14
    v_and_b32 v14, 0xffff0000, v14
    v_cvt_pk_bf16_f32 v12, v12, v12
    v_and_b32 v12, 0xffff0000, v12
    v_add_f32 v14, 0x3727c5ac, v14
    v_cvt_pk_bf16_f32 v14, v14, v14
    v_and_b32 v14, 0xffff0000, v14
    v_sqrt_f32 v14, v14
    v_sub_f32 v86, v86, v12
    v_sub_f32 v87, v87, v12
    v_sub_f32 v88, v88, v12
    v_sub_f32 v89, v89, v12
    v_sub_f32 v90, v90, v12
    v_sub_f32 v91, v91, v12
    v_sub_f32 v92, v92, v12
    v_sub_f32 v93, v93, v12
    v_sub_f32 v94, v94, v12
    v_sub_f32 v95, v95, v12
    v_cvt_pk_bf16_f32 v14, v14, v14
    v_and_b32 v14, 0xffff0000, v14
    v_rcp_f32 v14, v14
    v_cvt_pk_bf16_f32 v15, v86, v87
    v_lshlrev_b32 v86, 16, v15
    v_and_b32 v87, 0xffff0000, v15
    v_cvt_pk_bf16_f32 v15, v88, v89
    v_lshlrev_b32 v88, 16, v15
    v_and_b32 v89, 0xffff0000, v15
    v_cvt_pk_bf16_f32 v15, v90, v91
    v_lshlrev_b32 v90, 16, v15
    v_and_b32 v91, 0xffff0000, v15
    v_cvt_pk_bf16_f32 v15, v92, v93
    v_lshlrev_b32 v92, 16, v15
    v_and_b32 v93, 0xffff0000, v15
    v_cvt_pk_bf16_f32 v15, v94, v95
    v_lshlrev_b32 v94, 16, v15
    v_and_b32 v95, 0xffff0000, v15
    v_mul_f32 v86, v86, v14
    v_cvt_pk_bf16_f32 v86, v86, v86
    v_mul_f32 v87, v87, v14
    v_cvt_pk_bf16_f32 v87, v87, v87
    v_mul_f32 v88, v88, v14
    v_cvt_pk_bf16_f32 v88, v88, v88
    v_mul_f32 v89, v89, v14
    v_cvt_pk_bf16_f32 v89, v89, v89
    v_mul_f32 v90, v90, v14
    v_cvt_pk_bf16_f32 v90, v90, v90
    v_mul_f32 v91, v91, v14
    v_cvt_pk_bf16_f32 v91, v91, v91
    v_mul_f32 v92, v92, v14
    v_cvt_pk_bf16_f32 v92, v92, v92
    v_mul_f32 v93, v93, v14
    v_cvt_pk_bf16_f32 v93, v93, v93
    v_mul_f32 v94, v94, v14
    v_cvt_pk_bf16_f32 v94, v94, v94
    v_mul_f32 v95, v95, v14
    v_cvt_pk_bf16_f32 v95, v95, v95
    v_lshlrev_b32 v12, 5, v0
    v_lshlrev_b32 v13, 3, v0
    v_add_u32 v12, 153600, v12
    v_add_u32 v13, 155648, v13
    ds_write_b128 v12, v[86:89]
    ds_write_b128 v12, v[90:93] offset:16
    ds_write_b64 v13, v[94:95]
    s_lshl_b32 s68, s66, 5
    s_add_u32 s68, s68, 153600
    v_lshl_add_u32 v12, v1, 2, s68
    ds_read2_b32 v[96:97], v12 offset0:0 offset1:8
    ds_read2_b32 v[98:99], v12 offset0:16 offset1:24
    ds_read_b32 v100, v12 offset:128
    s_lshl_b32 s68, s71, 10
    s_and_b32 s69, s77, 1
    s_lshl_b32 s69, s69, 8
    s_add_u32 s68, s68, s69
    s_add_u32 s68, s68, 156160
    v_lshl_add_u32 v12, v11, 9, v10
    v_add_u32 v12, s68, v12
    s_lshl_b32 s68, s77, 7
    s_add_u32 s69, s68, 156160
    v_add_u32 v13, s69, v3
    s_lshl_b32 s74, s6, 3
    s_add_u32 s74, s74, s75
    s_lshl_b32 s74, s74, 9
    s_add_u32 s74, s74, s68
    s_add_u32 s74, s74, 5242880
    s_add_u32 s70, s74, 131072
    s_waitcnt lgkmcnt(0)
    s_load_dwordx2 s[24:25], s[0:1], 32
    s_load_dwordx2 s[28:29], s[0:1], 40
    s_load_dwordx2 s[32:33], s[0:1], 56
    s_load_dwordx2 s[36:37], s[0:1], 72
    s_load_dwordx2 s[40:41], s[0:1], 64
    s_load_dwordx2 s[48:49], s[0:1], 80
    s_load_dwordx2 s[52:53], s[0:1], 88
    v_and_b32 v124, v96, v4
    v_and_b32 v125, v96, v5
    v_and_b32 v126, v96, v6
    v_and_b32 v127, v96, v7
    v_and_b32 v128, v97, v4
    v_and_b32 v129, v97, v5
    v_and_b32 v130, v97, v6
    v_and_b32 v131, v97, v7
    v_and_b32 v132, v98, v4
    v_and_b32 v133, v98, v5
    v_and_b32 v134, v98, v6
    v_and_b32 v135, v98, v7
    v_and_b32 v136, v99, v4
    v_and_b32 v137, v99, v5
    v_and_b32 v138, v99, v6
    v_and_b32 v139, v99, v7
    v_and_b32 v140, v100, v4
    v_and_b32 v141, v100, v5
    v_and_b32 v142, v100, v6
    v_and_b32 v143, v100, v7
    s_waitcnt vmcnt(3)
    v_mfma_f32_16x16x32_bf16 v[144:147], v[124:127], v[104:107], 0
    s_cmp_lg_u32 s71, 0
    s_cbranch_scc1 L_b5_5
    v_mfma_f32_16x16x32_bf16 v[144:147], v[140:143], v[120:123], v[144:147]
L_b5_5:
    s_waitcnt vmcnt(2)
    v_mfma_f32_16x16x32_bf16 v[144:147], v[128:131], v[108:111], v[144:147]
    s_waitcnt vmcnt(1)
    v_mfma_f32_16x16x32_bf16 v[144:147], v[132:135], v[112:115], v[144:147]
    s_waitcnt vmcnt(0)
    v_mfma_f32_16x16x32_bf16 v[144:147], v[136:139], v[116:119], v[144:147]
    s_waitcnt vmcnt(0) lgkmcnt(0)
    v_readfirstlane_b32 s1, v31
    s_add_u32 s1, s1, 1
    s_and_b32 s60, s1, 0xff
    s_bfe_u32 s61, s1, 0x80008
    s_bfe_u32 s62, s1, 0x80010
    s_lshr_b32 s63, s1, 24
    s_mov_b32 exec_lo, 0x00ff00ff
    s_mov_b32 exec_hi, 0xff00ff00
    ds_write_b128 v12, v[144:147]
    s_mov_b64 exec, 1
    ds_add_u32 v8, v9 offset:0
    s_mov_b64 exec, -1
    s_mov_b32 s72, 4000000
L_lw_6:
    ds_read_b32 v14, v8 offset:0
    s_waitcnt lgkmcnt(0)
    v_readfirstlane_b32 s73, v14
    s_cmp_ge_u32 s73, 4
    s_cbranch_scc1 L_lwd_7
    s_sub_u32 s72, s72, 1
    s_cbranch_scc0 L_lw_6
L_lwd_7:
    s_mov_b64 exec, 0xff
    ds_read_b128 v[148:151], v13 offset:0
    ds_read_b128 v[152:155], v13 offset:512
    ds_read_b128 v[156:159], v13 offset:1024
    ds_read_b128 v[160:163], v13 offset:1536
    s_waitcnt lgkmcnt(2)
    v_pk_add_f32 v[148:149], v[148:149], v[152:153]
    v_pk_add_f32 v[150:151], v[150:151], v[154:155]
    s_waitcnt lgkmcnt(0)
    v_pk_add_f32 v[156:157], v[156:157], v[160:161]
    v_pk_add_f32 v[158:159], v[158:159], v[162:163]
    v_pk_add_f32 v[148:149], v[148:149], v[156:157]
    v_pk_add_f32 v[150:151], v[150:151], v[158:159]
    v_bfi_b32 v148, v43, s60, v148
    v_bfi_b32 v149, v43, s61, v149
    v_bfi_b32 v150, v43, s62, v150
    v_bfi_b32 v151, v43, s63, v151
    buffer_store_dwordx4 v[148:151], v3, s[12:15], s70 offen
    buffer_store_dwordx4 v[148:151], v3, s[12:15], s74 offen sc1
    s_mov_b64 exec, 1
    ds_add_u32 v8, v9 offset:8
    s_mov_b64 exec, -1
    s_setprio 1
    v_lshrrev_b32 v29, 4, v0
    v_and_b32 v30, 15, v0
    s_lshl_b32 s69, s77, 1
    s_add_u32 s69, s69, s58
    s_xor_b32 s68, s69, 1
    s_mul_i32 s68, s68, 16896
    v_mul_u32_u24 v16, 1056, v30
    v_lshlrev_b32 v12, 4, v29
    v_add3_u32 v16, v16, v12, s68
    v_lshrrev_b32 v12, 2, v0
    v_mul_u32_u24 v21, 1056, v12
    v_and_b32 v12, 3, v0
    v_lshlrev_b32 v12, 3, v12
    s_lshl_b32 s68, s69, 7
    v_add3_u32 v21, v21, v12, s68
    v_add_u32 v22, 67584, v21
    v_add_u32 v24, 156160, v3
    s_lshl_b32 s68, s77, 10
    s_xor_b32 s73, s58, 1
    s_lshl_b32 s73, s73, 3
    s_add_u32 s68, s68, s73
    v_add_u32 v23, s68, v24
    v_lshlrev_b32 v26, 3, v0
    v_add_u32 v26, 160256, v26
    s_lshl_b32 s68, s77, 9
    s_lshr_b32 s73, s73, 1
    s_add_u32 s68, s68, s73
    v_add_u32 v25, s68, v26
    v_xor_b32 v12, v29, v30
    v_lshl_add_u32 v12, v29, 4, v12
    v_lshlrev_b32 v12, 4, v12
    v_xor_b32 v17, 0, v12
    v_add_u32 v17, 135168, v17
    v_xor_b32 v18, 64, v12
    v_add_u32 v18, 135168, v18
    v_xor_b32 v19, 128, v12
    v_add_u32 v19, 135168, v19
    v_xor_b32 v20, 192, v12
    v_add_u32 v20, 135168, v20
    v_and_b32 v27, 7, v30
    v_lshlrev_b32 v27, 17, v27
    v_lshl_add_u32 v27, v29, 4, v27
    v_lshrrev_b32 v14, 3, v30
    v_lshl_add_u32 v27, v14, 6, v27
    v_lshl_add_u32 v14, v14, 2, v29
    v_and_b32 v12, 3, v14
    v_lshlrev_b32 v12, 3, v12
    v_lshrrev_b32 v12, v12, s1
    v_lshrrev_b32 v13, 2, v14
    v_sub_u32 v13, 0, v13
    v_xor_b32 v12, v12, v13
    v_bfe_u32 v36, v12, 0, 1
    v_bfe_u32 v13, v12, 1, 1
    v_lshl_or_b32 v36, v13, 16, v36
    v_bfe_u32 v37, v12, 2, 1
    v_bfe_u32 v13, v12, 3, 1
    v_lshl_or_b32 v37, v13, 16, v37
    v_bfe_u32 v38, v12, 4, 1
    v_bfe_u32 v13, v12, 5, 1
    v_lshl_or_b32 v38, v13, 16, v38
    v_bfe_u32 v39, v12, 6, 1
    v_bfe_u32 v13, v12, 7, 1
    v_lshl_or_b32 v39, v13, 16, v39
    v_lshlrev_b32 v28, 4, v30
    v_lshlrev_b32 v30, 2, v30
    v_add_u32 v30, 162304, v30
    v_bfe_u32 v12, v0, 1, 4
    s_lshl_b32 s68, s77, 2
    v_xor_b32 v12, s68, v12
    v_lshlrev_b32 v12, 4, v12
    v_bfe_u32 v13, v0, 1, 2
    v_lshl_add_u32 v13, v1, 2, v13
    v_lshlrev_b32 v13, 8, v13
    v_and_b32 v14, 1, v0
    v_lshl_add_u32 v13, v14, 3, v13
    v_add_u32 v13, 135168, v13
    v_xor_b32 v44, 0, v12
    v_add_u32 v44, v44, v13
    v_xor_b32 v45, 16, v12
    v_add_u32 v45, v45, v13
    v_xor_b32 v46, 32, v12
    v_add_u32 v46, v46, v13
    v_xor_b32 v47, 48, v12
    v_add_u32 v47, v47, v13
    s_lshl_b32 s76, s64, 15
    s_lshl_b32 s69, s77, 13
    s_add_u32 s76, s76, s69
    s_add_u32 s76, s76, 4096
    s_add_u32 s68, s76, 4096
    s_mov_b32 s67, 0x07060302
    s_cmp_eq_u32 s64, 0
    s_cselect_b32 s69, 4, 4
    v_add_u32 v15, s69, v8
    s_mov_b32 s72, 4000000
L_lw_8:
    ds_read_b32 v14, v15 offset:0
    s_waitcnt lgkmcnt(0)
    v_readfirstlane_b32 s73, v14
    s_cmp_ge_u32 s73, 4
    s_cbranch_scc1 L_lwd_9
    s_sleep 1
    s_sub_u32 s72, s72, 1
    s_cbranch_scc0 L_lw_8
L_lwd_9:
    s_setprio 3
    buffer_load_dwordx4 v[208:211], v3, s[12:15], s76 offen offset:0 sc1
    buffer_load_dwordx4 v[212:215], v3, s[12:15], s76 offen offset:1024 sc1
    buffer_load_dwordx4 v[216:219], v3, s[12:15], s76 offen offset:2048 sc1
    buffer_load_dwordx4 v[220:223], v3, s[12:15], s76 offen offset:3072 sc1
    buffer_load_dwordx4 v[224:227], v3, s[12:15], s68 offen offset:0 sc1
    buffer_load_dwordx4 v[228:231], v3, s[12:15], s68 offen offset:1024 sc1
    buffer_load_dwordx4 v[232:235], v3, s[12:15], s68 offen offset:2048 sc1
    buffer_load_dwordx4 v[236:239], v3, s[12:15], s68 offen offset:3072 sc1
    s_mov_b64 exec, 1
    ds_add_u32 v8, v9 offset:20
    s_mov_b64 exec, -1
    ds_read_b128 v[80:83], v16 offset:0
    ds_read_b128 v[84:87], v16 offset:64
    ds_read_b128 v[88:91], v16 offset:128
    ds_read_b128 v[92:95], v16 offset:192
    ds_read_b128 v[96:99], v16 offset:256
    ds_read_b128 v[100:103], v16 offset:320
    ds_read_b128 v[104:107], v16 offset:384
    ds_read_b128 v[108:111], v16 offset:448
    ds_read_b128 v[112:115], v16 offset:512
    ds_read_b128 v[116:119], v16 offset:576
    ds_read_b128 v[120:123], v16 offset:640
    ds_read_b128 v[124:127], v16 offset:704
    ds_read_b128 v[128:131], v16 offset:768
    ds_read_b128 v[132:135], v16 offset:832
    ds_read_b128 v[136:139], v16 offset:896
    ds_read_b128 v[140:143], v16 offset:960
    s_mov_b32 s72, 4000000
L_lw_11:
    ds_read_b32 v14, v8 offset:4
    s_waitcnt lgkmcnt(0)
    v_readfirstlane_b32 s73, v14
    s_cmp_ge_u32 s73, 4
    s_cbranch_scc1 L_lwd_12
    s_sub_u32 s72, s72, 1
    s_cbranch_scc0 L_lw_11
L_lwd_12:
    ds_read_b64_tr_b16 v[144:145], v21 offset:0
    ds_read_b64_tr_b16 v[146:147], v21 offset:16896
    ds_read_b64_tr_b16 v[148:149], v21 offset:32
    ds_read_b64_tr_b16 v[150:151], v21 offset:16928
    ds_read_b64_tr_b16 v[152:153], v21 offset:64
    ds_read_b64_tr_b16 v[154:155], v21 offset:16960
    ds_read_b64_tr_b16 v[156:157], v21 offset:96
    ds_read_b64_tr_b16 v[158:159], v21 offset:16992
    ds_read_b64_tr_b16 v[160:161], v21 offset:33792
    ds_read_b64_tr_b16 v[162:163], v21 offset:50688
    ds_read_b64_tr_b16 v[164:165], v21 offset:33824
    ds_read_b64_tr_b16 v[166:167], v21 offset:50720
    ds_read_b64_tr_b16 v[168:169], v21 offset:33856
    ds_read_b64_tr_b16 v[170:171], v21 offset:50752
    ds_read_b64_tr_b16 v[172:173], v21 offset:33888
    ds_read_b64_tr_b16 v[174:175], v21 offset:50784
    ds_read_b64_tr_b16 v[176:177], v22 offset:0
    ds_read_b64_tr_b16 v[178:179], v22 offset:16896
    ds_read_b64_tr_b16 v[180:181], v22 offset:32
    ds_read_b64_tr_b16 v[182:183], v22 offset:16928
    ds_read_b64_tr_b16 v[184:185], v22 offset:64
    ds_read_b64_tr_b16 v[186:187], v22 offset:16960
    ds_read_b64_tr_b16 v[188:189], v22 offset:96
    ds_read_b64_tr_b16 v[190:191], v22 offset:16992
    ds_read_b64_tr_b16 v[192:193], v22 offset:33792
    ds_read_b64_tr_b16 v[194:195], v22 offset:50688
    ds_read_b64_tr_b16 v[196:197], v22 offset:33824
    ds_read_b64_tr_b16 v[198:199], v22 offset:50720
    ds_read_b64_tr_b16 v[200:201], v22 offset:33856
    ds_read_b64_tr_b16 v[202:203], v22 offset:50752
    ds_read_b64_tr_b16 v[204:205], v22 offset:33888
    ds_read_b64_tr_b16 v[206:207], v22 offset:50784
    s_waitcnt vmcnt(7)
    v_perm_b32 v240, v209, v208, s67
    v_perm_b32 v241, v211, v210, s67
    ds_write_b64 v44, v[240:241] offset:0
    v_xor_b32 v14, s60, v208
    v_bitop3_b32 v14, v14, v209, s61 bitop3:0xf6
    v_bitop3_b32 v14, v14, v210, s62 bitop3:0xf6
    v_bitop3_b32 v14, v14, v211, s63 bitop3:0xf6
    s_waitcnt vmcnt(6)
    v_perm_b32 v242, v213, v212, s67
    v_perm_b32 v243, v215, v214, s67
    ds_write_b64 v44, v[242:243] offset:8192
    v_bitop3_b32 v14, v14, v212, s60 bitop3:0xf6
    v_bitop3_b32 v14, v14, v213, s61 bitop3:0xf6
    v_bitop3_b32 v14, v14, v214, s62 bitop3:0xf6
    v_bitop3_b32 v14, v14, v215, s63 bitop3:0xf6
    s_waitcnt vmcnt(5)
    v_perm_b32 v244, v217, v216, s67
    v_perm_b32 v245, v219, v218, s67
    ds_write_b64 v45, v[244:245] offset:0
    v_bitop3_b32 v14, v14, v216, s60 bitop3:0xf6
    v_bitop3_b32 v14, v14, v217, s61 bitop3:0xf6
    v_bitop3_b32 v14, v14, v218, s62 bitop3:0xf6
    v_bitop3_b32 v14, v14, v219, s63 bitop3:0xf6
    s_waitcnt vmcnt(4)
    v_perm_b32 v246, v221, v220, s67
    v_perm_b32 v247, v223, v222, s67
    ds_write_b64 v45, v[246:247] offset:8192
    v_bitop3_b32 v14, v14, v220, s60 bitop3:0xf6
    v_bitop3_b32 v14, v14, v221, s61 bitop3:0xf6
    v_bitop3_b32 v14, v14, v222, s62 bitop3:0xf6
    v_bitop3_b32 v14, v14, v223, s63 bitop3:0xf6
    s_waitcnt vmcnt(3)
    v_perm_b32 v248, v225, v224, s67
    v_perm_b32 v249, v227, v226, s67
    ds_write_b64 v46, v[248:249] offset:0
    v_bitop3_b32 v14, v14, v224, s60 bitop3:0xf6
    v_bitop3_b32 v14, v14, v225, s61 bitop3:0xf6
    v_bitop3_b32 v14, v14, v226, s62 bitop3:0xf6
    v_bitop3_b32 v14, v14, v227, s63 bitop3:0xf6
    s_waitcnt vmcnt(2)
    v_perm_b32 v250, v229, v228, s67
    v_perm_b32 v251, v231, v230, s67
    ds_write_b64 v46, v[250:251] offset:8192
    v_bitop3_b32 v14, v14, v228, s60 bitop3:0xf6
    v_bitop3_b32 v14, v14, v229, s61 bitop3:0xf6
    v_bitop3_b32 v14, v14, v230, s62 bitop3:0xf6
    v_bitop3_b32 v14, v14, v231, s63 bitop3:0xf6
    s_waitcnt vmcnt(1)
    v_perm_b32 v252, v233, v232, s67
    v_perm_b32 v253, v235, v234, s67
    ds_write_b64 v47, v[252:253] offset:0
    v_bitop3_b32 v14, v14, v232, s60 bitop3:0xf6
    v_bitop3_b32 v14, v14, v233, s61 bitop3:0xf6
    v_bitop3_b32 v14, v14, v234, s62 bitop3:0xf6
    v_bitop3_b32 v14, v14, v235, s63 bitop3:0xf6
    s_waitcnt vmcnt(0)
    v_perm_b32 v254, v237, v236, s67
    v_perm_b32 v255, v239, v238, s67
    ds_write_b64 v47, v[254:255] offset:8192
    v_bitop3_b32 v14, v14, v236, s60 bitop3:0xf6
    v_bitop3_b32 v14, v14, v237, s61 bitop3:0xf6
    v_bitop3_b32 v14, v14, v238, s62 bitop3:0xf6
    v_bitop3_b32 v14, v14, v239, s63 bitop3:0xf6
    v_and_b32 v14, 0xff, v14
    v_cmp_ne_u32 vcc, 0, v14
    s_cbranch_vccz L_qok_10
    s_mov_b64 exec, vcc
    s_mov_b32 s72, 400000
L_pl_13:
    buffer_load_dwordx4 v[208:211], v3, s[12:15], s76 offen offset:0 sc1
    buffer_load_dwordx4 v[212:215], v3, s[12:15], s76 offen offset:1024 sc1
    buffer_load_dwordx4 v[216:219], v3, s[12:15], s76 offen offset:2048 sc1
    buffer_load_dwordx4 v[220:223], v3, s[12:15], s76 offen offset:3072 sc1
    buffer_load_dwordx4 v[224:227], v3, s[12:15], s68 offen offset:0 sc1
    buffer_load_dwordx4 v[228:231], v3, s[12:15], s68 offen offset:1024 sc1
    buffer_load_dwordx4 v[232:235], v3, s[12:15], s68 offen offset:2048 sc1
    buffer_load_dwordx4 v[236:239], v3, s[12:15], s68 offen offset:3072 sc1
    s_waitcnt vmcnt(0)
    v_xor_b32 v14, s60, v208
    v_bitop3_b32 v14, v14, v209, s61 bitop3:0xf6
    v_bitop3_b32 v14, v14, v210, s62 bitop3:0xf6
    v_bitop3_b32 v14, v14, v211, s63 bitop3:0xf6
    v_bitop3_b32 v14, v14, v212, s60 bitop3:0xf6
    v_bitop3_b32 v14, v14, v213, s61 bitop3:0xf6
    v_bitop3_b32 v14, v14, v214, s62 bitop3:0xf6
    v_bitop3_b32 v14, v14, v215, s63 bitop3:0xf6
    v_bitop3_b32 v14, v14, v216, s60 bitop3:0xf6
    v_bitop3_b32 v14, v14, v217, s61 bitop3:0xf6
    v_bitop3_b32 v14, v14, v218, s62 bitop3:0xf6
    v_bitop3_b32 v14, v14, v219, s63 bitop3:0xf6
    v_bitop3_b32 v14, v14, v220, s60 bitop3:0xf6
    v_bitop3_b32 v14, v14, v221, s61 bitop3:0xf6
    v_bitop3_b32 v14, v14, v222, s62 bitop3:0xf6
    v_bitop3_b32 v14, v14, v223, s63 bitop3:0xf6
    v_bitop3_b32 v14, v14, v224, s60 bitop3:0xf6
    v_bitop3_b32 v14, v14, v225, s61 bitop3:0xf6
    v_bitop3_b32 v14, v14, v226, s62 bitop3:0xf6
    v_bitop3_b32 v14, v14, v227, s63 bitop3:0xf6
    v_bitop3_b32 v14, v14, v228, s60 bitop3:0xf6
    v_bitop3_b32 v14, v14, v229, s61 bitop3:0xf6
    v_bitop3_b32 v14, v14, v230, s62 bitop3:0xf6
    v_bitop3_b32 v14, v14, v231, s63 bitop3:0xf6
    v_bitop3_b32 v14, v14, v232, s60 bitop3:0xf6
    v_bitop3_b32 v14, v14, v233, s61 bitop3:0xf6
    v_bitop3_b32 v14, v14, v234, s62 bitop3:0xf6
    v_bitop3_b32 v14, v14, v235, s63 bitop3:0xf6
    v_bitop3_b32 v14, v14, v236, s60 bitop3:0xf6
    v_bitop3_b32 v14, v14, v237, s61 bitop3:0xf6
    v_bitop3_b32 v14, v14, v238, s62 bitop3:0xf6
    v_bitop3_b32 v14, v14, v239, s63 bitop3:0xf6
    v_and_b32 v14, 0xff, v14
    v_cmp_ne_u32 vcc, 0, v14
    s_and_b64 exec, exec, vcc
    s_cbranch_execz L_pld_14
    s_sub_u32 s72, s72, 1
    s_cbranch_scc0 L_pl_13
L_pld_14:
    s_mov_b64 exec, -1
    v_perm_b32 v240, v209, v208, s67
    v_perm_b32 v241, v211, v210, s67
    ds_write_b64 v44, v[240:241] offset:0
    v_perm_b32 v242, v213, v212, s67
    v_perm_b32 v243, v215, v214, s67
    ds_write_b64 v44, v[242:243] offset:8192
    v_perm_b32 v244, v217, v216, s67
    v_perm_b32 v245, v219, v218, s67
    ds_write_b64 v45, v[244:245] offset:0
    v_perm_b32 v246, v221, v220, s67
    v_perm_b32 v247, v223, v222, s67
    ds_write_b64 v45, v[246:247] offset:8192
    v_perm_b32 v248, v225, v224, s67
    v_perm_b32 v249, v227, v226, s67
    ds_write_b64 v46, v[248:249] offset:0
    v_perm_b32 v250, v229, v228, s67
    v_perm_b32 v251, v231, v230, s67
    ds_write_b64 v46, v[250:251] offset:8192
    v_perm_b32 v252, v233, v232, s67
    v_perm_b32 v253, v235, v234, s67
    ds_write_b64 v47, v[252:253] offset:0
    v_perm_b32 v254, v237, v236, s67
    v_perm_b32 v255, v239, v238, s67
    ds_write_b64 v47, v[254:255] offset:8192
L_qok_10:
    s_mov_b32 s74, 0x3db504f3
    s_mov_b32 s75, 0x3fb8aa3b
    s_lshl_b32 s71, s64, 6
    s_add_u32 s71, s71, s77
    s_lshl_b32 s71, s71, 15
    s_lshl_b32 s68, s65, 8
    s_add_u32 s71, s71, s68
    s_lshl_b32 s69, s58, 7
    s_add_u32 s71, s71, s69
    s_add_u32 s71, s71, 1048576
    s_lshl_b32 s70, s64, 15
    s_add_u32 s70, s70, s68
    s_add_u32 s70, s70, 200704
    s_waitcnt lgkmcnt(0)
    s_barrier
    s_setprio 2
L_ATT:
    ds_read_b128 v[48:51], v17 offset:0
    ds_read_b128 v[52:55], v18 offset:1024
    ds_read_b128 v[56:59], v19 offset:2048
    ds_read_b128 v[60:63], v20 offset:3072
    ds_read_b128 v[64:67], v17 offset:4096
    ds_read_b128 v[68:71], v18 offset:5120
    ds_read_b128 v[72:75], v19 offset:6144
    ds_read_b128 v[76:79], v20 offset:7168
    s_waitcnt lgkmcnt(7)
    v_mfma_f32_16x16x32_bf16 v[32:35], v[80:83], v[48:51], 0
    s_waitcnt lgkmcnt(6)
    v_mfma_f32_16x16x32_bf16 v[32:35], v[84:87], v[52:55], v[32:35]
    ds_read_b128 v[48:51], v17 offset:8192
    s_waitcnt lgkmcnt(6)
    v_mfma_f32_16x16x32_bf16 v[32:35], v[88:91], v[56:59], v[32:35]
    ds_read_b128 v[52:55], v18 offset:9216
    s_waitcnt lgkmcnt(6)
    v_mfma_f32_16x16x32_bf16 v[32:35], v[92:95], v[60:63], v[32:35]
    ds_read_b128 v[56:59], v19 offset:10240
    s_waitcnt lgkmcnt(6)
    v_mfma_f32_16x16x32_bf16 v[32:35], v[96:99], v[64:67], v[32:35]
    ds_read_b128 v[60:63], v20 offset:11264
    s_waitcnt lgkmcnt(6)
    v_mfma_f32_16x16x32_bf16 v[32:35], v[100:103], v[68:71], v[32:35]
    ds_read_b128 v[64:67], v17 offset:12288
    s_waitcnt lgkmcnt(6)
    v_mfma_f32_16x16x32_bf16 v[32:35], v[104:107], v[72:75], v[32:35]
    ds_read_b128 v[68:71], v18 offset:13312
    s_waitcnt lgkmcnt(6)
    v_mfma_f32_16x16x32_bf16 v[32:35], v[108:111], v[76:79], v[32:35]
    ds_read_b128 v[72:75], v19 offset:14336
    s_waitcnt lgkmcnt(6)
    v_mfma_f32_16x16x32_bf16 v[32:35], v[112:115], v[48:51], v[32:35]
    ds_read_b128 v[76:79], v20 offset:15360
    s_waitcnt lgkmcnt(6)
    v_mfma_f32_16x16x32_bf16 v[32:35], v[116:119], v[52:55], v[32:35]
    s_waitcnt lgkmcnt(5)
    v_mfma_f32_16x16x32_bf16 v[32:35], v[120:123], v[56:59], v[32:35]
    s_waitcnt lgkmcnt(4)
    v_mfma_f32_16x16x32_bf16 v[32:35], v[124:127], v[60:63], v[32:35]
    s_waitcnt lgkmcnt(3)
    v_mfma_f32_16x16x32_bf16 v[32:35], v[128:131], v[64:67], v[32:35]
    s_waitcnt lgkmcnt(2)
    v_mfma_f32_16x16x32_bf16 v[32:35], v[132:135], v[68:71], v[32:35]
    s_waitcnt lgkmcnt(1)
    v_mfma_f32_16x16x32_bf16 v[32:35], v[136:139], v[72:75], v[32:35]
    s_waitcnt lgkmcnt(0)
    v_mfma_f32_16x16x32_bf16 v[32:35], v[140:143], v[76:79], v[32:35]
    s_setprio 1
    s_nop 6
    v_cvt_pk_bf16_f32 v12, v32, v33
    v_cvt_pk_bf16_f32 v13, v34, v35
    v_lshlrev_b32 v32, 16, v12
    v_and_b32 v33, 0xffff0000, v12
    v_lshlrev_b32 v34, 16, v13
    v_and_b32 v35, 0xffff0000, v13
    v_mul_f32 v32, s74, v32
    v_mul_f32 v33, s74, v33
    v_mul_f32 v34, s74, v34
    v_mul_f32 v35, s74, v35
    v_cvt_pk_bf16_f32 v12, v32, v33
    v_cvt_pk_bf16_f32 v13, v34, v35
    v_lshlrev_b32 v32, 16, v12
    v_and_b32 v33, 0xffff0000, v12
    v_lshlrev_b32 v34, 16, v13
    v_and_b32 v35, 0xffff0000, v13
    v_max3_f32 v12, v32, v33, v34
    v_max_f32 v12, v12, v35
    v_mul_f32 v12, s75, v12
    v_ceil_f32 v12, v12
    v_fma_f32 v32, v32, s75, -v12
    v_fma_f32 v33, v33, s75, -v12
    v_fma_f32 v34, v34, s75, -v12
    v_fma_f32 v35, v35, s75, -v12
    v_cvt_i32_f32 v12, v12
    v_exp_f32 v32, v32
    v_exp_f32 v33, v33
    v_exp_f32 v34, v34
    v_exp_f32 v35, v35
    v_lshlrev_b32 v12, 7, v12
    ds_max_i32 v30, v12
    ds_write_b32 v25, v12
    v_cvt_pk_bf16_f32 v14, v32, v33
    v_cvt_pk_bf16_f32 v15, v34, v35
    ds_write_b64 v23, v[14:15]
    s_cmp_eq_u32 s58, 0
    s_cbranch_scc1 L_SL2
L_SL2R:
    s_mov_b32 s74, 0x07060302
    s_mov_b32 s75, 0x10001
    s_waitcnt lgkmcnt(0)
    s_barrier
    s_setprio 3
    s_cmp_eq_u32 s58, 0
    s_cbranch_scc1 L_ap_15
    s_setprio 2
L_ap_15:
    ds_read_b32 v12, v30
    ds_read_b64 v[112:113], v26 offset:0
    ds_read_b64 v[114:115], v26 offset:512
    ds_read_b64 v[116:117], v26 offset:1024
    ds_read_b64 v[118:119], v26 offset:1536
    ds_read_b128 v[80:83], v24 offset:0
    ds_read_b128 v[84:87], v24 offset:1024
    ds_read_b128 v[88:91], v24 offset:2048
    ds_read_b128 v[92:95], v24 offset:3072
    s_waitcnt lgkmcnt(7)
    v_sub_u32 v112, v12, v112
    v_sub_u32 v113, v12, v113
    v_cvt_pk_u16_u32 v136, v112, v113
    s_waitcnt lgkmcnt(6)
    v_sub_u32 v114, v12, v114
    v_sub_u32 v115, v12, v115
    v_cvt_pk_u16_u32 v137, v114, v115
    s_waitcnt lgkmcnt(5)
    v_sub_u32 v116, v12, v116
    v_sub_u32 v117, v12, v117
    v_cvt_pk_u16_u32 v138, v116, v117
    s_waitcnt lgkmcnt(4)
    v_sub_u32 v118, v12, v118
    v_sub_u32 v119, v12, v119
    v_cvt_pk_u16_u32 v139, v118, v119
    s_cmp_eq_u32 s3, 3
    s_cbranch_scc1 L_PVS
    s_waitcnt lgkmcnt(3)
    v_pk_sub_u16 v80, v80, v136 op_sel:[0,0] op_sel_hi:[1,0] clamp
    v_pk_sub_u16 v81, v81, v136 op_sel:[0,0] op_sel_hi:[1,0] clamp
    v_pk_sub_u16 v82, v82, v136 op_sel:[0,1] op_sel_hi:[1,1] clamp
    v_pk_sub_u16 v83, v83, v136 op_sel:[0,1] op_sel_hi:[1,1] clamp
    s_waitcnt lgkmcnt(2)
    s_nop 0
    v_mfma_f32_16x16x32_bf16 v[96:99], v[144:147], v[80:83], 0
    v_pk_sub_u16 v84, v84, v137 op_sel:[0,0] op_sel_hi:[1,0] clamp
    v_mfma_f32_16x16x32_bf16 v[100:103], v[148:151], v[80:83], 0
    v_pk_sub_u16 v85, v85, v137 op_sel:[0,0] op_sel_hi:[1,0] clamp
    v_mfma_f32_16x16x32_bf16 v[104:107], v[152:155], v[80:83], 0
    v_pk_sub_u16 v86, v86, v137 op_sel:[0,1] op_sel_hi:[1,1] clamp
    v_mfma_f32_16x16x32_bf16 v[108:111], v[156:159], v[80:83], 0
    v_pk_sub_u16 v87, v87, v137 op_sel:[0,1] op_sel_hi:[1,1] clamp
    s_waitcnt lgkmcnt(1)
    s_nop 0
    v_mfma_f32_16x16x32_bf16 v[96:99], v[160:163], v[84:87], v[96:99]
    v_pk_sub_u16 v88, v88, v138 op_sel:[0,0] op_sel_hi:[1,0] clamp
    v_mfma_f32_16x16x32_bf16 v[100:103], v[164:167], v[84:87], v[100:103]
    v_pk_sub_u16 v89, v89, v138 op_sel:[0,0] op_sel_hi:[1,0] clamp
    v_mfma_f32_16x16x32_bf16 v[104:107], v[168:171], v[84:87], v[104:107]
    v_pk_sub_u16 v90, v90, v138 op_sel:[0,1] op_sel_hi:[1,1] clamp
    v_mfma_f32_16x16x32_bf16 v[108:111], v[172:175], v[84:87], v[108:111]
    v_pk_sub_u16 v91, v91, v138 op_sel:[0,1] op_sel_hi:[1,1] clamp
    s_waitcnt lgkmcnt(0)
    s_nop 0
    v_mfma_f32_16x16x32_bf16 v[96:99], v[176:179], v[88:91], v[96:99]
    v_pk_sub_u16 v92, v92, v139 op_sel:[0,0] op_sel_hi:[1,0] clamp
    v_mfma_f32_16x16x32_bf16 v[100:103], v[180:183], v[88:91], v[100:103]
    v_pk_sub_u16 v93, v93, v139 op_sel:[0,0] op_sel_hi:[1,0] clamp
    v_mfma_f32_16x16x32_bf16 v[104:107], v[184:187], v[88:91], v[104:107]
    v_pk_sub_u16 v94, v94, v139 op_sel:[0,1] op_sel_hi:[1,1] clamp
    v_mfma_f32_16x16x32_bf16 v[108:111], v[188:191], v[88:91], v[108:111]
    v_pk_sub_u16 v95, v95, v139 op_sel:[0,1] op_sel_hi:[1,1] clamp
    s_nop 1
    v_mfma_f32_16x16x32_bf16 v[96:99], v[192:195], v[92:95], v[96:99]
    v_mfma_f32_16x16x32_bf16 v[100:103], v[196:199], v[92:95], v[100:103]
    v_mfma_f32_16x16x32_bf16 v[104:107], v[200:203], v[92:95], v[104:107]
    v_mfma_f32_16x16x32_bf16 v[108:111], v[204:207], v[92:95], v[108:111]
L_PVE:
    s_nop 4
    v_perm_b32 v128, v97, v96, s74
    v_perm_b32 v129, v99, v98, s74
    v_perm_b32 v130, v101, v100, s74
    v_perm_b32 v131, v103, v102, s74
    v_perm_b32 v132, v105, v104, s74
    v_perm_b32 v133, v107, v106, s74
    v_perm_b32 v134, v109, v108, s74
    v_perm_b32 v135, v111, v110, s74
    v_pk_add_u16 v128, v128, s75
    v_pk_add_u16 v129, v129, s75
    v_pk_add_u16 v130, v130, s75
    v_pk_add_u16 v131, v131, s75
    v_pk_add_u16 v132, v132, s75
    v_pk_add_u16 v133, v133, s75
    v_pk_add_u16 v134, v134, s75
    v_pk_add_u16 v135, v135, s75
    v_mov_b32 v112, v128
    v_mov_b32 v113, v129
    v_mov_b32 v114, v130
    v_mov_b32 v115, v131
    v_mov_b32_dpp v128, v132 row_ror:8 row_mask:0xf bank_mask:0xc
    v_mov_b32_dpp v129, v133 row_ror:8 row_mask:0xf bank_mask:0xc
    v_mov_b32_dpp v130, v134 row_ror:8 row_mask:0xf bank_mask:0xc
    v_mov_b32_dpp v131, v135 row_ror:8 row_mask:0xf bank_mask:0xc
    v_mov_b32_dpp v132, v112 row_ror:8 row_mask:0xf bank_mask:0x3
    v_mov_b32_dpp v133, v113 row_ror:8 row_mask:0xf bank_mask:0x3
    v_mov_b32_dpp v134, v114 row_ror:8 row_mask:0xf bank_mask:0x3
    v_mov_b32_dpp v135, v115 row_ror:8 row_mask:0xf bank_mask:0x3
    v_bfi_b32 v128, s75, v36, v128
    v_bfi_b32 v129, s75, v37, v129
    v_bfi_b32 v130, s75, v38, v130
    v_bfi_b32 v131, s75, v39, v131
    buffer_store_dwordx4 v[128:131], v27, s[12:15], s71 offen sc1
    s_add_u32 s71, s71, 1048576
    v_bfi_b32 v132, s75, v36, v132
    v_bfi_b32 v133, s75, v37, v133
    v_bfi_b32 v134, s75, v38, v134
    v_bfi_b32 v135, s75, v39, v135
    buffer_store_dwordx4 v[132:135], v27, s[12:15], s71 offen sc1
    s_mov_b64 exec, 1
    ds_add_u32 v8, v9 offset:28
    s_mov_b64 exec, -1
    s_cmp_eq_u32 s58, 0
    s_cbranch_scc1 L_G2
    s_cmp_lg_u32 s64, 0
    s_cbranch_scc1 L_fin
    s_mov_b32 s67, s65
    s_cmp_eq_u32 s77, 0
    s_cbranch_scc1 L_f1_16
    s_cmp_lg_u32 s77, 1
    s_cbranch_scc1 L_fin
    s_cmp_ge_u32 s5, 2
    s_cbranch_scc1 L_fin
    s_lshl_b32 s67, s4, 1
    s_add_u32 s67, s67, s5
    s_add_u32 s67, s67, 128
L_f1_16:
    s_setprio 0
    s_lshl_b32 s68, s67, 3
    v_lshlrev_b32 v16, 1, v29
    buffer_load_ushort v14, v16, s[8:11], s68 offen
    buffer_load_ushort v15, v16, s[48:51], s68 offen
    v_mul_u32_u24 v13, 2304, v0
    s_lshl_b32 s70, s67, 4
    s_add_u32 s71, s70, 266240
    s_add_u32 s70, s70, 561152
    s_add_u32 s74, s71, 147456
    s_add_u32 s75, s70, 147456
    s_barrier
    s_barrier
    s_waitcnt vmcnt(0)
    v_lshlrev_b32 v15, 16, v15
    v_lshlrev_b32 v14, 16, v14
    s_mov_b32 s72, 4000000
L_lw_17:
    ds_read_b32 v12, v8 offset:32
    s_waitcnt lgkmcnt(0)
    v_readfirstlane_b32 s73, v12
    s_cmp_ge_u32 s73, 4
    s_cbranch_scc1 L_lwd_18
    s_sleep 1
    s_sub_u32 s72, s72, 1
    s_cbranch_scc0 L_lw_17
L_lwd_18:
    s_setprio 3
    s_mov_b32 s72, 400000
L_pl_19:
    v_mov_b32 v92, s60
    v_mov_b32 v93, s61
    v_mov_b32 v94, s62
    v_mov_b32 v95, s63
    buffer_load_dwordx4 v[88:91], v13, s[12:15], s70 offen sc1
    s_mov_b64 s[78:79], exec
    s_and_b64 exec, exec, 0xff
    s_cbranch_execz L_fys_21
    buffer_load_dwordx4 v[92:95], v13, s[12:15], s75 offen sc1
L_fys_21:
    s_mov_b64 exec, s[78:79]
    s_waitcnt vmcnt(0)
    v_xor_b32 v88, s60, v88
    v_xor_b32 v89, s61, v89
    v_xor_b32 v90, s62, v90
    v_xor_b32 v91, s63, v91
    v_xor_b32 v92, s60, v92
    v_xor_b32 v93, s61, v93
    v_xor_b32 v94, s62, v94
    v_xor_b32 v95, s63, v95
    v_or_b32 v12, v88, v89
    v_or3_b32 v12, v12, v90, v91
    v_or3_b32 v12, v12, v92, v93
    v_or3_b32 v12, v12, v94, v95
    v_and_b32 v12, 0xff, v12
    v_cmp_ne_u32 vcc, 0, v12
    s_and_b64 exec, exec, vcc
    s_cbranch_execz L_pld_20
    s_sub_u32 s72, s72, 1
    s_cbranch_scc0 L_pl_19
L_pld_20:
    s_mov_b64 exec, -1
    v_pk_add_f32 v[88:89], v[88:89], v[92:93]
    v_pk_add_f32 v[90:91], v[90:91], v[94:95]
    s_nop 1
    v_permlane32_swap_b32 v88, v90
    v_permlane32_swap_b32 v89, v91
    v_add_f32 v88, v88, v90
    v_add_f32 v89, v89, v91
    s_nop 1
    v_permlane16_swap_b32 v88, v89
    v_add_f32 v88, v88, v89
    s_nop 1
    v_add_f32_dpp v88, v88, v88 row_ror:8 row_mask:0xf bank_mask:0xf
    s_nop 1
    v_add_f32_dpp v88, v88, v88 row_ror:4 row_mask:0xf bank_mask:0xf
    s_nop 1
    v_add_f32_dpp v88, v88, v88 row_ror:2 row_mask:0xf bank_mask:0xf
    s_nop 1
    v_add_f32_dpp v88, v88, v88 row_ror:1 row_mask:0xf bank_mask:0xf
    v_cvt_pk_bf16_f32 v88, v88, v88
    v_and_b32 v88, 0xffff0000, v88
    v_add_f32 v18, v88, v15
    v_cvt_pk_bf16_f32 v18, v18, v18
    v_and_b32 v18, 0xffff0000, v18
    v_mul_f32 v19, 0xbfb8aa3b, v18
    v_exp_f32 v19, v19
    s_nop 0
    v_add_f32 v19, 1.0, v19
    v_rcp_f32 v19, v19
    s_nop 0
    v_mul_f32 v18, v18, v19
    v_cvt_pk_bf16_f32 v18, v18, v18
    v_and_b32 v18, 0xffff0000, v18
    s_mov_b32 s72, 400000
L_pl_22:
    buffer_load_dwordx4 v[80:83], v13, s[12:15], s71 offen sc1
    buffer_load_dwordx4 v[84:87], v13, s[12:15], s74 offen sc1
    s_waitcnt vmcnt(0)
    v_xor_b32 v80, s60, v80
    v_xor_b32 v81, s61, v81
    v_xor_b32 v82, s62, v82
    v_xor_b32 v83, s63, v83
    v_xor_b32 v84, s60, v84
    v_xor_b32 v85, s61, v85
    v_xor_b32 v86, s62, v86
    v_xor_b32 v87, s63, v87
    v_or_b32 v12, v80, v81
    v_or3_b32 v12, v12, v82, v83
    v_or3_b32 v12, v12, v84, v85
    v_or3_b32 v12, v12, v86, v87
    v_and_b32 v12, 0xff, v12
    v_cmp_ne_u32 vcc, 0, v12
    s_and_b64 exec, exec, vcc
    s_cbranch_execz L_pld_23
    s_sub_u32 s72, s72, 1
    s_cbranch_scc0 L_pl_22
L_pld_23:
    s_mov_b64 exec, -1
    s_cmp_lg_u32 s67, 0
    s_cbranch_scc1 L_ep_24
    v_mov_b32 v20, s1
    s_mov_b64 exec, 1
    buffer_store_dword v20, off, s[12:15], 0 sc1
    s_mov_b64 exec, -1
L_ep_24:
    v_pk_add_f32 v[80:81], v[80:81], v[84:85]
    v_pk_add_f32 v[82:83], v[82:83], v[86:87]
    s_nop 1
    v_permlane32_swap_b32 v80, v82
    v_permlane32_swap_b32 v81, v83
    v_add_f32 v80, v80, v82
    v_add_f32 v81, v81, v83
    s_nop 1
    v_permlane16_swap_b32 v80, v81
    v_add_f32 v80, v80, v81
    s_nop 1
    v_add_f32_dpp v80, v80, v80 row_ror:8 row_mask:0xf bank_mask:0xf
    s_nop 1
    v_add_f32_dpp v80, v80, v80 row_ror:4 row_mask:0xf bank_mask:0xf
    s_nop 1
    v_add_f32_dpp v80, v80, v80 row_ror:2 row_mask:0xf bank_mask:0xf
    s_nop 1
    v_add_f32_dpp v80, v80, v80 row_ror:1 row_mask:0xf bank_mask:0xf
    v_cvt_pk_bf16_f32 v80, v80, v80
    v_and_b32 v80, 0xffff0000, v80
    v_mul_f32 v80, v80, v18
    v_cvt_pk_bf16_f32 v80, v80, v80
    v_and_b32 v80, 0xffff0000, v80
    v_add_f32 v80, v80, v14
    v_cvt_pk_bf16_f32 v80, v80, v80
    s_lshl_b32 s68, s67, 3
    s_mov_b32 exec_lo, 0x00010001
    s_mov_b32 exec_hi, 0x00010001
    buffer_store_short v80, v16, s[52:55], s68 offen
L_fin:
    s_endpgm
L_GX1:
    s_movk_i32 s67, 1024
    s_lshl_b32 s59, s6, 2
    s_add_u32 s59, s59, s7
    s_lshl_b32 s66, s59, 2
    s_add_u32 s66, s66, s77
    s_lshl_b32 s66, s66, 7
    v_lshlrev_b32 v42, 2, v0
    s_load_dwordx2 s[24:25], s[0:1], 32
    s_load_dwordx2 s[28:29], s[0:1], 40
    s_load_dwordx2 s[32:33], s[0:1], 56
    s_load_dwordx2 s[36:37], s[0:1], 72
    s_load_dwordx2 s[40:41], s[0:1], 64
    s_load_dwordx2 s[48:49], s[0:1], 80
    s_load_dwordx2 s[52:53], s[0:1], 88
    s_mov_b32 s26, 4194304
    s_mov_b32 s27, 0x20000
    s_mov_b32 s30, 4718592
    s_mov_b32 s31, 0x20000
    s_mov_b32 s34, 5308416
    s_mov_b32 s35, 0x20000
    s_mov_b32 s38, 5308416
    s_mov_b32 s39, 0x20000
    s_mov_b32 s42, 9216
    s_mov_b32 s43, 0x20000
    s_mov_b32 s50, 1152
    s_mov_b32 s51, 0x20000
    s_mov_b32 s54, 1152
    s_mov_b32 s55, 0x20000
    v_mov_b32 v40, 0
    v_mov_b32 v144, -1
    v_mov_b32 v145, -1
    v_mov_b32 v146, -1
    v_mov_b32 v147, -1
    s_lshl_b32 s75, s66, 2
    s_add_u32 s75, s75, 5505024
    s_add_u32 s74, s66, 4096
    s_mov_b32 exec_hi, 0
    buffer_store_dwordx4 v[144:147], v3, s[12:15], s75 offen sc1
    s_add_u32 s75, s75, 262144
    buffer_store_dwordx4 v[144:147], v3, s[12:15], s75 offen sc1
    s_mov_b64 exec, -1
    v_and_b32 v12, 1, v0
    v_mov_b32 v13, 0xffff
    v_lshlrev_b32 v12, 4, v12
    v_lshlrev_b32 v12, v12, v13
    v_bfe_u32 v13, v0, 1, 2
    v_cmp_eq_u32 vcc, 0, v13
    s_nop 1
    v_cndmask_b32 v4, 0, v12, vcc
    v_cmp_eq_u32 vcc, 1, v13
    s_nop 1
    v_cndmask_b32 v5, 0, v12, vcc
    v_cmp_eq_u32 vcc, 2, v13
    s_nop 1
    v_cndmask_b32 v6, 0, v12, vcc
    v_cmp_eq_u32 vcc, 3, v13
    s_nop 1
    v_cndmask_b32 v7, 0, v12, vcc
    v_mov_b32 v8, 163648
    v_mov_b32 v9, 1
    v_mov_b32 v43, 0xff
    v_lshrrev_b32 v11, 5, v0
    v_bfe_u32 v12, v0, 4, 1
    v_lshlrev_b32 v12, 4, v12
    v_lshl_add_u32 v10, v2, 5, v12
    s_lshl_b32 s75, s6, 12
    s_add_u32 s75, s75, 5373952
    v_and_b32 v16, 31, v0
    v_lshlrev_b32 v16, 3, v16
    v_add_u32 v16, 163328, v16
    v_lshlrev_b32 v17, 4, v15
    v_add_u32 v18, 163328, v17
    v_and_b32 v19, 1, v0
    v_lshl_add_u32 v17, v19, 6, v17
    v_cmp_eq_u32 s[78:79], 1, v19
    v_mov_b32 v20, 0xffff
    v_lshl_add_u32 v18, v19, 6, v18
    v_bfe_u32 v21, v0, 1, 2
    v_bfe_u32 v17, v0, 4, 1
    v_lshlrev_b32 v17, 4, v17
    v_lshl_add_u32 v17, v21, 5, v17
    v_cmp_eq_u32 s[56:57], 1, v21
    v_cmp_eq_u32 s[78:79], 2, v21
    v_cmp_eq_u32 s[100:101], 3, v21
    s_waitcnt vmcnt(10) lgkmcnt(0)
    v_readfirstlane_b32 s1, v31
    s_add_u32 s1, s1, 1
    s_and_b32 s60, s1, 0xff
    s_bfe_u32 s61, s1, 0x80008
    s_bfe_u32 s62, s1, 0x80010
    s_lshr_b32 s63, s1, 24
    s_mov_b32 s72, 4000000
L_lw_27:
    ds_read_b32 v12, v8 offset:8
    s_waitcnt lgkmcnt(0)
    v_readfirstlane_b32 s73, v12
    s_cmp_ge_u32 s73, 4
    s_cbranch_scc1 L_lwd_28
    s_sub_u32 s72, s72, 1
    s_cbranch_scc0 L_lw_27
L_lwd_28:
    s_setprio 3
    s_mov_b32 s72, 400000
L_pl_29:
    s_and_b32 s73, s72, 7
    s_cmp_eq_u32 s73, 1
    s_cselect_b32 s73, 131072, 0
    s_xor_b32 s73, s73, s75
    buffer_load_dwordx4 v[128:131], v3, s[12:15], s73 offen offset:0 sc1
    buffer_load_dwordx4 v[132:135], v3, s[12:15], s73 offen offset:1024 sc1
    buffer_load_dwordx4 v[136:139], v3, s[12:15], s73 offen offset:2048 sc1
    buffer_load_dwordx4 v[140:143], v3, s[12:15], s73 offen offset:3072 sc1
    s_waitcnt vmcnt(0)
    v_xor_b32 v128, s60, v128
    v_xor_b32 v129, s61, v129
    v_xor_b32 v130, s62, v130
    v_xor_b32 v131, s63, v131
    v_xor_b32 v132, s60, v132
    v_xor_b32 v133, s61, v133
    v_xor_b32 v134, s62, v134
    v_xor_b32 v135, s63, v135
    v_xor_b32 v136, s60, v136
    v_xor_b32 v137, s61, v137
    v_xor_b32 v138, s62, v138
    v_xor_b32 v139, s63, v139
    v_xor_b32 v140, s60, v140
    v_xor_b32 v141, s61, v141
    v_xor_b32 v142, s62, v142
    v_xor_b32 v143, s63, v143
    v_or_b32 v13, v128, v129
    v_or3_b32 v13, v13, v130, v131
    v_or3_b32 v13, v13, v132, v133
    v_or3_b32 v13, v13, v134, v135
    v_or3_b32 v13, v13, v136, v137
    v_or3_b32 v13, v13, v138, v139
    v_or3_b32 v13, v13, v140, v141
    v_or3_b32 v13, v13, v142, v143
    v_and_b32 v13, 0xff, v13
    v_cmp_ne_u32 vcc, 0, v13
    s_and_b64 exec, exec, vcc
    s_cbranch_execz L_pld_30
    s_sub_u32 s72, s72, 1
    s_cbranch_scc0 L_pl_29
L_pld_30:
    s_mov_b64 exec, -1
    v_pk_add_f32 v[128:129], v[128:129], v[132:133]
    v_pk_add_f32 v[130:131], v[130:131], v[134:135]
    v_pk_add_f32 v[136:137], v[136:137], v[140:141]
    v_pk_add_f32 v[138:139], v[138:139], v[142:143]
    v_pk_add_f32 v[128:129], v[128:129], v[136:137]
    v_pk_add_f32 v[130:131], v[130:131], v[138:139]
    v_mov_b32 v132, v128
    v_mov_b32 v133, v129
    v_mov_b32 v134, v130
    v_mov_b32 v135, v131
    v_permlane32_swap_b32 v128, v132
    v_permlane32_swap_b32 v129, v133
    v_permlane32_swap_b32 v130, v134
    v_permlane32_swap_b32 v131, v135
    v_pk_add_f32 v[128:129], v[128:129], v[132:133]
    v_pk_add_f32 v[130:131], v[130:131], v[134:135]
    v_cvt_pk_bf16_f32 v128, v128, v129
    v_cvt_pk_bf16_f32 v129, v130, v131
    ds_write_b64 v16, v[128:129]
    ds_read_b128 v[112:115], v18 offset:0
    ds_read_b128 v[116:119], v18 offset:128
    s_waitcnt lgkmcnt(1)
    v_mfma_f32_16x16x32_bf16 v[144:147], v[80:83], v[112:115], 0
    v_mfma_f32_16x16x32_bf16 v[148:151], v[88:91], v[112:115], 0
    v_mfma_f32_16x16x32_bf16 v[152:155], v[96:99], v[112:115], 0
    v_mfma_f32_16x16x32_bf16 v[156:159], v[104:107], v[112:115], 0
    s_waitcnt lgkmcnt(0)
    v_mfma_f32_16x16x32_bf16 v[144:147], v[84:87], v[116:119], v[144:147]
    v_mfma_f32_16x16x32_bf16 v[148:151], v[92:95], v[116:119], v[148:151]
    v_mfma_f32_16x16x32_bf16 v[152:155], v[100:103], v[116:119], v[152:155]
    v_mfma_f32_16x16x32_bf16 v[156:159], v[108:111], v[116:119], v[156:159]
    s_nop 5
    v_cndmask_b32 v144, v144, v148, s[56:57]
    v_cndmask_b32 v145, v145, v149, s[56:57]
    v_cndmask_b32 v146, v146, v150, s[56:57]
    v_cndmask_b32 v147, v147, v151, s[56:57]
    v_cndmask_b32 v144, v144, v152, s[78:79]
    v_cndmask_b32 v145, v145, v153, s[78:79]
    v_cndmask_b32 v146, v146, v154, s[78:79]
    v_cndmask_b32 v147, v147, v155, s[78:79]
    v_cndmask_b32 v144, v144, v156, s[100:101]
    v_cndmask_b32 v145, v145, v157, s[100:101]
    v_cndmask_b32 v146, v146, v158, s[100:101]
    v_cndmask_b32 v147, v147, v159, s[100:101]
    v_mov_b32 v148, v144
    v_mov_b32 v149, v145
    v_mov_b32 v150, v146
    v_mov_b32 v151, v147
    v_permlane32_swap_b32 v144, v148
    v_permlane32_swap_b32 v145, v149
    v_permlane32_swap_b32 v146, v150
    v_permlane32_swap_b32 v147, v151
    v_add_f32_dpp v144, v148, v144 quad_perm:[1,0,3,2] row_mask:0xf bank_mask:0xf
    v_add_f32_dpp v145, v149, v145 quad_perm:[1,0,3,2] row_mask:0xf bank_mask:0xf
    v_add_f32_dpp v146, v150, v146 quad_perm:[1,0,3,2] row_mask:0xf bank_mask:0xf
    v_add_f32_dpp v147, v151, v147 quad_perm:[1,0,3,2] row_mask:0xf bank_mask:0xf
    v_cvt_pk_bf16_f32 v144, v144, v144
    v_cvt_pk_bf16_f32 v145, v145, v145
    v_cvt_pk_bf16_f32 v146, v146, v146
    v_cvt_pk_bf16_f32 v147, v147, v147
    v_bfi_b32 v144, v20, s60, v144
    v_bfi_b32 v145, v20, s61, v145
    v_bfi_b32 v146, v20, s62, v146
    v_bfi_b32 v147, v20, s63, v147
    s_mov_b32 exec_lo, 0x00550055
    s_mov_b32 exec_hi, 0x00000000
    buffer_store_dwordx4 v[144:147], v17, s[12:15], s74 offen sc1
    s_mov_b64 exec, -1
    s_setprio 2
    s_mov_b32 s68, 0
L_dma_31:
    s_mov_b32 m0, s71
    s_add_u32 s71, s71, 1056
    buffer_load_dwordx4 v3, s[44:47], s70 offen lds
    s_add_u32 s70, s70, s67
    s_waitcnt vmcnt(12)
    s_add_u32 s68, s68, 1
    s_cmp_lt_u32 s68, 10
    s_cbranch_scc1 L_dma_31
    s_mov_b32 s76, 10
    s_branch L_gy2_26
L_GY1:
    s_movk_i32 s67, 1024
    s_add_u32 s71, s71, 1056
    s_add_u32 s70, s70, 1024
    v_lshlrev_b32 v42, 2, v0
    s_load_dwordx2 s[24:25], s[0:1], 32
    s_load_dwordx2 s[28:29], s[0:1], 40
    s_load_dwordx2 s[32:33], s[0:1], 56
    s_load_dwordx2 s[36:37], s[0:1], 72
    s_load_dwordx2 s[40:41], s[0:1], 64
    s_load_dwordx2 s[48:49], s[0:1], 80
    s_load_dwordx2 s[52:53], s[0:1], 88
    s_mov_b32 s26, 4194304
    s_mov_b32 s27, 0x20000
    s_mov_b32 s30, 4718592
    s_mov_b32 s31, 0x20000
    s_mov_b32 s34, 5308416
    s_mov_b32 s35, 0x20000
    s_mov_b32 s38, 5308416
    s_mov_b32 s39, 0x20000
    s_mov_b32 s42, 9216
    s_mov_b32 s43, 0x20000
    s_mov_b32 s50, 1152
    s_mov_b32 s51, 0x20000
    s_mov_b32 s54, 1152
    s_mov_b32 s55, 0x20000
    v_mov_b32 v40, 0
    s_waitcnt vmcnt(0) lgkmcnt(0)
    s_setprio 2
    s_mov_b32 s68, 1
L_dma_32:
    s_mov_b32 m0, s71
    s_add_u32 s71, s71, 1056
    buffer_load_dwordx4 v3, s[44:47], s70 offen lds
    s_add_u32 s70, s70, s67
    s_waitcnt vmcnt(12)
    s_add_u32 s68, s68, 1
    s_cmp_lt_u32 s68, 10
    s_cbranch_scc1 L_dma_32
    s_lshl_b32 s59, s6, 2
    s_add_u32 s59, s59, s7
    v_and_b32 v12, 1, v0
    v_mov_b32 v13, 0xffff
    v_lshlrev_b32 v12, 4, v12
    v_lshlrev_b32 v12, v12, v13
    v_bfe_u32 v13, v0, 1, 2
    v_cmp_eq_u32 vcc, 0, v13
    s_nop 1
    v_cndmask_b32 v4, 0, v12, vcc
    v_cmp_eq_u32 vcc, 1, v13
    s_nop 1
    v_cndmask_b32 v5, 0, v12, vcc
    v_cmp_eq_u32 vcc, 2, v13
    s_nop 1
    v_cndmask_b32 v6, 0, v12, vcc
    v_cmp_eq_u32 vcc, 3, v13
    s_nop 1
    v_cndmask_b32 v7, 0, v12, vcc
    v_mov_b32 v8, 163648
    v_mov_b32 v9, 1
    v_mov_b32 v43, 0xff
    v_lshrrev_b32 v11, 5, v0
    v_bfe_u32 v12, v0, 4, 1
    v_lshlrev_b32 v12, 4, v12
    v_lshl_add_u32 v10, v2, 5, v12
    v_readfirstlane_b32 s1, v31
    s_add_u32 s1, s1, 1
    s_and_b32 s60, s1, 0xff
    s_bfe_u32 s61, s1, 0x80008
    s_bfe_u32 s62, s1, 0x80010
    s_lshr_b32 s63, s1, 24
    s_mov_b32 s76, 10
L_gy2_26:
    v_lshrrev_b32 v29, 4, v0
    v_and_b32 v30, 15, v0
    s_lshl_b32 s69, s77, 1
    s_add_u32 s69, s69, s58
    s_xor_b32 s68, s69, 1
    s_mul_i32 s68, s68, 16896
    v_mul_u32_u24 v16, 1056, v30
    v_lshlrev_b32 v12, 4, v29
    v_add3_u32 v16, v16, v12, s68
    v_lshrrev_b32 v12, 2, v0
    v_mul_u32_u24 v21, 1056, v12
    v_and_b32 v12, 3, v0
    v_lshlrev_b32 v12, 3, v12
    s_lshl_b32 s68, s69, 7
    v_add3_u32 v21, v21, v12, s68
    v_add_u32 v22, 67584, v21
    v_add_u32 v24, 156160, v3
    s_lshl_b32 s68, s77, 10
    s_xor_b32 s73, s58, 1
    s_lshl_b32 s73, s73, 3
    s_add_u32 s68, s68, s73
    v_add_u32 v23, s68, v24
    v_lshlrev_b32 v26, 3, v0
    v_add_u32 v26, 160256, v26
    s_lshl_b32 s68, s77, 9
    s_lshr_b32 s73, s73, 1
    s_add_u32 s68, s68, s73
    v_add_u32 v25, s68, v26
    v_xor_b32 v12, v29, v30
    v_lshl_add_u32 v12, v29, 4, v12
    v_lshlrev_b32 v12, 4, v12
    v_xor_b32 v17, 0, v12
    v_add_u32 v17, 135168, v17
    v_xor_b32 v18, 64, v12
    v_add_u32 v18, 135168, v18
    v_xor_b32 v19, 128, v12
    v_add_u32 v19, 135168, v19
    v_xor_b32 v20, 192, v12
    v_add_u32 v20, 135168, v20
    v_and_b32 v27, 7, v30
    v_lshlrev_b32 v27, 17, v27
    v_lshl_add_u32 v27, v29, 4, v27
    v_lshrrev_b32 v14, 3, v30
    v_lshl_add_u32 v27, v14, 6, v27
    v_lshl_add_u32 v14, v14, 2, v29
    v_and_b32 v12, 3, v14
    v_lshlrev_b32 v12, 3, v12
    v_lshrrev_b32 v12, v12, s1
    v_lshrrev_b32 v13, 2, v14
    v_sub_u32 v13, 0, v13
    v_xor_b32 v12, v12, v13
    v_bfe_u32 v36, v12, 0, 1
    v_bfe_u32 v13, v12, 1, 1
    v_lshl_or_b32 v36, v13, 16, v36
    v_bfe_u32 v37, v12, 2, 1
    v_bfe_u32 v13, v12, 3, 1
    v_lshl_or_b32 v37, v13, 16, v37
    v_bfe_u32 v38, v12, 4, 1
    v_bfe_u32 v13, v12, 5, 1
    v_lshl_or_b32 v38, v13, 16, v38
    v_bfe_u32 v39, v12, 6, 1
    v_bfe_u32 v13, v12, 7, 1
    v_lshl_or_b32 v39, v13, 16, v39
    v_lshlrev_b32 v28, 4, v30
    v_lshlrev_b32 v30, 2, v30
    v_add_u32 v30, 162304, v30
    v_mov_b32 v44, 0x3f803f80
    v_mov_b32 v45, 0x3f803f80
    v_mov_b32 v46, 0x3f803f80
    v_mov_b32 v47, 0x3f803f80
    v_and_b32 v12, 1, v1
    v_lshlrev_b32 v12, 4, v12
    v_lshrrev_b32 v13, 1, v1
    v_lshl_add_u32 v12, v13, 2, v12
    v_lshlrev_b32 v12, 13, v12
    v_lshl_add_u32 v15, v2, 4, v12
    s_mul_i32 s68, s64, 161280
    s_add_u32 s68, s68, 4608
    v_mul_u32_u24 v40, s68, v1
    v_lshl_add_u32 v40, v2, 4, v40
    s_lshl_b32 s74, s7, 1
    s_lshr_b32 s69, s77, 1
    s_add_u32 s74, s74, s69
    s_lshl_b32 s74, s74, 1
    s_and_b32 s69, s77, 1
    s_add_u32 s74, s74, s69
    s_lshl_b32 s74, s74, 18
    s_lshl_b32 s69, s6, 8
    s_add_u32 s74, s74, s69
    s_mul_i32 s57, s59, 36864
    s_lshl_b32 s68, s77, 7
    s_add_u32 s57, s57, s68
    s_mul_i32 s66, s4, 9
    s_add_u32 s66, s66, s5
    s_sub_u32 s66, s66, 16
    s_lshl_b32 s75, s66, 7
    s_mul_i32 s56, s77, 1327104
    s_add_u32 s56, s56, s75
    s_mov_b32 s68, s76
L_dma_33:
    s_mov_b32 m0, s71
    s_add_u32 s71, s71, 1056
    buffer_load_dwordx4 v3, s[44:47], s70 offen lds
    s_add_u32 s70, s70, s67
    s_waitcnt vmcnt(12)
    s_add_u32 s68, s68, 1
    s_cmp_lt_u32 s68, 32
    s_cbranch_scc1 L_dma_33
    s_mov_b64 exec, 1
    ds_add_u32 v8, v9 offset:12
    s_mov_b64 exec, -1
    s_setprio 3
    s_mov_b32 s72, 4000000
L_lw_34:
    ds_read_b32 v12, v8 offset:8
    s_waitcnt lgkmcnt(0)
    v_readfirstlane_b32 s73, v12
    s_cmp_ge_u32 s73, 4
    s_cbranch_scc1 L_lwd_35
    s_sub_u32 s72, s72, 1
    s_cbranch_scc0 L_lw_34
L_lwd_35:
    s_waitcnt vmcnt(0)
    s_mov_b64 exec, 1
    ds_add_u32 v8, v9 offset:4
    s_mov_b64 exec, -1
    ds_read_b128 v[80:83], v16 offset:0
    ds_read_b128 v[84:87], v16 offset:64
    ds_read_b128 v[88:91], v16 offset:128
    ds_read_b128 v[92:95], v16 offset:192
    ds_read_b128 v[96:99], v16 offset:256
    ds_read_b128 v[100:103], v16 offset:320
    ds_read_b128 v[104:107], v16 offset:384
    ds_read_b128 v[108:111], v16 offset:448
    ds_read_b128 v[112:115], v16 offset:512
    ds_read_b128 v[116:119], v16 offset:576
    ds_read_b128 v[120:123], v16 offset:640
    ds_read_b128 v[124:127], v16 offset:704
    ds_read_b128 v[128:131], v16 offset:768
    ds_read_b128 v[132:135], v16 offset:832
    ds_read_b128 v[136:139], v16 offset:896
    ds_read_b128 v[140:143], v16 offset:960
    s_setprio 0
    s_mov_b32 s72, 4000000
L_lw_36:
    ds_read_b32 v12, v8 offset:20
    s_waitcnt lgkmcnt(0)
    v_readfirstlane_b32 s73, v12
    s_cmp_ge_u32 s73, 4
    s_cbranch_scc1 L_lwd_37
    s_sub_u32 s72, s72, 1
    s_cbranch_scc0 L_lw_36
L_lwd_37:
    s_cmp_lg_u32 s64, 0
    s_cbranch_scc1 L_wy_38
    buffer_load_dwordx4 v[208:211], v15, s[24:27], s74 offen offset:0
    buffer_load_dwordx4 v[212:215], v15, s[24:27], s74 offen offset:128
    s_add_u32 s74, s74, 8192
    buffer_load_dwordx4 v[216:219], v15, s[24:27], s74 offen offset:0
    buffer_load_dwordx4 v[220:223], v15, s[24:27], s74 offen offset:128
    s_add_u32 s74, s74, 8192
    buffer_load_dwordx4 v[224:227], v15, s[24:27], s74 offen offset:0
    buffer_load_dwordx4 v[228:231], v15, s[24:27], s74 offen offset:128
    s_add_u32 s74, s74, 8192
    buffer_load_dwordx4 v[232:235], v15, s[24:27], s74 offen offset:0
    buffer_load_dwordx4 v[236:239], v15, s[24:27], s74 offen offset:128
    s_branch L_wd_40
L_wy_38:
    s_cmp_ge_u32 s5, 25
    s_cbranch_scc1 L_wh_39
    v_lshlrev_b32 v12, 1, v0
    buffer_load_ushort v41, v12, s[40:43], s75 offen
    buffer_load_dwordx4 v[208:211], v40, s[32:35], s56 offen
    s_add_u32 s56, s56, 9216
    buffer_load_dwordx4 v[212:215], v40, s[32:35], s56 offen
    s_add_u32 s56, s56, 9216
    buffer_load_dwordx4 v[216:219], v40, s[32:35], s56 offen
    s_add_u32 s56, s56, 9216
    buffer_load_dwordx4 v[220:223], v40, s[32:35], s56 offen
    s_add_u32 s56, s56, 9216
    buffer_load_dwordx4 v[224:227], v40, s[32:35], s56 offen
    s_add_u32 s56, s56, 9216
    buffer_load_dwordx4 v[228:231], v40, s[32:35], s56 offen
    s_add_u32 s56, s56, 9216
    buffer_load_dwordx4 v[232:235], v40, s[32:35], s56 offen
    s_add_u32 s56, s56, 9216
    buffer_load_dwordx4 v[236:239], v40, s[32:35], s56 offen
    s_add_u32 s56, s56, 9216
    s_branch L_wd_40
L_wh_39:
    s_sub_u32 s56, s5, 25
    s_lshl_b32 s56, s56, 2
    s_add_u32 s56, s56, s77
    s_mul_i32 s57, s56, 29
    s_lshr_b32 s57, s57, 8
    s_mul_i32 s69, s57, 9
    s_sub_u32 s56, s56, s69
    s_mul_i32 s59, s4, 663552
    s_lshr_b32 s68, s32, 7
    s_mul_i32 s74, s4, 9
    s_add_u32 s68, s68, s74
    s_sub_u32 s68, 3, s68
    s_and_b32 s68, s68, 7
    s_cmp_eq_u32 s68, 0
    s_cselect_b32 s76, 80, 40
    s_add_u32 s74, s74, s68
    s_lshl_b32 s74, s74, 7
    s_sub_u32 s75, s5, 25
    s_lshl_b32 s75, s75, 2
    s_add_u32 s75, s75, s77
L_spf_41:
    s_cmp_ge_u32 s75, 40
    s_cselect_b32 s68, 40, 0
    s_cselect_b32 s69, 1024, 0
    s_sub_u32 s68, s75, s68
    s_mul_i32 s70, s68, 6554
    s_lshr_b32 s70, s70, 16
    s_mul_i32 s70, s70, 134
    s_add_u32 s68, s68, s70
    s_add_u32 s68, s68, 8
    s_mul_i32 s68, s68, 9216
    s_add_u32 s68, s68, s69
    s_add_u32 s68, s68, s74
    buffer_load_dwordx4 v[208:211], v40, s[32:35], s68 offen
    s_add_u32 s75, s75, 28
    s_cmp_lt_u32 s75, s76
    s_cbranch_scc1 L_spf_41
    s_mul_i32 s68, s56, 73728
    s_lshl_b32 s69, s57, 10
    s_add_u32 s68, s68, s69
    s_add_u32 s68, s68, s59
    buffer_load_dwordx4 v[208:211], v3, s[36:39], s68 offen
    s_add_u32 s56, s56, 1
    s_cmp_eq_u32 s56, 9
    s_cselect_b32 s56, 0, s56
    s_addc_u32 s57, s57, 3
    s_mul_i32 s68, s56, 73728
    s_lshl_b32 s69, s57, 10
    s_add_u32 s68, s68, s69
    s_add_u32 s68, s68, s59
    buffer_load_dwordx4 v[208:211], v3, s[36:39], s68 offen
    s_add_u32 s56, s56, 1
    s_cmp_eq_u32 s56, 9
    s_cselect_b32 s56, 0, s56
    s_addc_u32 s57, s57, 3
    s_mul_i32 s68, s56, 73728
    s_lshl_b32 s69, s57, 10
    s_add_u32 s68, s68, s69
    s_add_u32 s68, s68, s59
    buffer_load_dwordx4 v[208:211], v3, s[36:39], s68 offen
    s_add_u32 s56, s56, 1
    s_cmp_eq_u32 s56, 9
    s_cselect_b32 s56, 0, s56
    s_addc_u32 s57, s57, 3
    s_mul_i32 s68, s56, 73728
    s_lshl_b32 s69, s57, 10
    s_add_u32 s68, s68, s69
    s_add_u32 s68, s68, s59
    buffer_load_dwordx4 v[208:211], v3, s[36:39], s68 offen
    s_add_u32 s56, s56, 1
    s_cmp_eq_u32 s56, 9
    s_cselect_b32 s56, 0, s56
    s_addc_u32 s57, s57, 3
    s_mul_i32 s68, s56, 73728
    s_lshl_b32 s69, s57, 10
    s_add_u32 s68, s68, s69
    s_add_u32 s68, s68, s59
    buffer_load_dwordx4 v[208:211], v3, s[36:39], s68 offen
    s_add_u32 s56, s56, 1
    s_cmp_eq_u32 s56, 9
    s_cselect_b32 s56, 0, s56
    s_addc_u32 s57, s57, 3
    s_mul_i32 s68, s56, 73728
    s_lshl_b32 s69, s57, 10
    s_add_u32 s68, s68, s69
    s_add_u32 s68, s68, s59
    buffer_load_dwordx4 v[208:211], v3, s[36:39], s68 offen
    s_add_u32 s56, s56, 1
    s_cmp_eq_u32 s56, 9
    s_cselect_b32 s56, 0, s56
    s_addc_u32 s57, s57, 3
L_wd_40:
    s_mov_b32 s74, 0x3db504f3
    s_mov_b32 s75, 0x3fb8aa3b
    s_lshl_b32 s71, s64, 6
    s_add_u32 s71, s71, s77
    s_lshl_b32 s71, s71, 15
    s_lshl_b32 s68, s65, 8
    s_add_u32 s71, s71, s68
    s_lshl_b32 s69, s58, 7
    s_add_u32 s71, s71, s69
    s_add_u32 s71, s71, 1048576
    s_lshl_b32 s70, s64, 15
    s_add_u32 s70, s70, s68
    s_add_u32 s70, s70, 200704
    s_mov_b32 s72, 4000000
L_lw_43:
    ds_read_b32 v12, v8 offset:4
    s_waitcnt lgkmcnt(0)
    v_readfirstlane_b32 s73, v12
    s_cmp_ge_u32 s73, 4
    s_cbranch_scc1 L_lwd_44
    s_sub_u32 s72, s72, 1
    s_cbranch_scc0 L_lw_43
L_lwd_44:
    ds_read_b64_tr_b16 v[144:145], v21 offset:0
    ds_read_b64_tr_b16 v[146:147], v21 offset:16896
    ds_read_b64_tr_b16 v[148:149], v21 offset:32
    ds_read_b64_tr_b16 v[150:151], v21 offset:16928
    ds_read_b64_tr_b16 v[152:153], v21 offset:64
    ds_read_b64_tr_b16 v[154:155], v21 offset:16960
    ds_read_b64_tr_b16 v[156:157], v21 offset:96
    ds_read_b64_tr_b16 v[158:159], v21 offset:16992
    ds_read_b64_tr_b16 v[160:161], v21 offset:33792
    ds_read_b64_tr_b16 v[162:163], v21 offset:50688
    ds_read_b64_tr_b16 v[164:165], v21 offset:33824
    ds_read_b64_tr_b16 v[166:167], v21 offset:50720
    ds_read_b64_tr_b16 v[168:169], v21 offset:33856
    ds_read_b64_tr_b16 v[170:171], v21 offset:50752
    ds_read_b64_tr_b16 v[172:173], v21 offset:33888
    ds_read_b64_tr_b16 v[174:175], v21 offset:50784
    ds_read_b64_tr_b16 v[176:177], v22 offset:0
    ds_read_b64_tr_b16 v[178:179], v22 offset:16896
    ds_read_b64_tr_b16 v[180:181], v22 offset:32
    ds_read_b64_tr_b16 v[182:183], v22 offset:16928
    ds_read_b64_tr_b16 v[184:185], v22 offset:64
    ds_read_b64_tr_b16 v[186:187], v22 offset:16960
    ds_read_b64_tr_b16 v[188:189], v22 offset:96
    ds_read_b64_tr_b16 v[190:191], v22 offset:16992
    ds_read_b64_tr_b16 v[192:193], v22 offset:33792
    ds_read_b64_tr_b16 v[194:195], v22 offset:50688
    ds_read_b64_tr_b16 v[196:197], v22 offset:33824
    ds_read_b64_tr_b16 v[198:199], v22 offset:50720
    ds_read_b64_tr_b16 v[200:201], v22 offset:33856
    ds_read_b64_tr_b16 v[202:203], v22 offset:50752
    ds_read_b64_tr_b16 v[204:205], v22 offset:33888
    ds_read_b64_tr_b16 v[206:207], v22 offset:50784
    s_barrier
    s_setprio 3
    s_branch L_ATT
L_PVS:
    s_waitcnt lgkmcnt(3)
    v_pk_sub_u16 v80, v80, v136 op_sel:[0,0] op_sel_hi:[1,0] clamp
    v_pk_sub_u16 v81, v81, v136 op_sel:[0,0] op_sel_hi:[1,0] clamp
    v_pk_sub_u16 v82, v82, v136 op_sel:[0,1] op_sel_hi:[1,1] clamp
    v_pk_sub_u16 v83, v83, v136 op_sel:[0,1] op_sel_hi:[1,1] clamp
    s_waitcnt lgkmcnt(2)
    v_pk_sub_u16 v84, v84, v137 op_sel:[0,0] op_sel_hi:[1,0] clamp
    v_pk_sub_u16 v85, v85, v137 op_sel:[0,0] op_sel_hi:[1,0] clamp
    v_pk_sub_u16 v86, v86, v137 op_sel:[0,1] op_sel_hi:[1,1] clamp
    v_pk_sub_u16 v87, v87, v137 op_sel:[0,1] op_sel_hi:[1,1] clamp
    v_mfma_f32_16x16x32_bf16 v[32:35], v[44:47], v[80:83], 0
    s_waitcnt lgkmcnt(1)
    v_pk_sub_u16 v88, v88, v138 op_sel:[0,0] op_sel_hi:[1,0] clamp
    v_pk_sub_u16 v89, v89, v138 op_sel:[0,0] op_sel_hi:[1,0] clamp
    v_pk_sub_u16 v90, v90, v138 op_sel:[0,1] op_sel_hi:[1,1] clamp
    v_pk_sub_u16 v91, v91, v138 op_sel:[0,1] op_sel_hi:[1,1] clamp
    v_mfma_f32_16x16x32_bf16 v[32:35], v[44:47], v[84:87], v[32:35]
    s_waitcnt lgkmcnt(0)
    v_pk_sub_u16 v92, v92, v139 op_sel:[0,0] op_sel_hi:[1,0] clamp
    v_pk_sub_u16 v93, v93, v139 op_sel:[0,0] op_sel_hi:[1,0] clamp
    v_pk_sub_u16 v94, v94, v139 op_sel:[0,1] op_sel_hi:[1,1] clamp
    v_pk_sub_u16 v95, v95, v139 op_sel:[0,1] op_sel_hi:[1,1] clamp
    v_mfma_f32_16x16x32_bf16 v[32:35], v[44:47], v[88:91], v[32:35]
    v_ashrrev_i32 v12, 7, v12
    v_mov_b32 v14, s1
    v_mfma_f32_16x16x32_bf16 v[32:35], v[44:47], v[92:95], v[32:35]
    v_cvt_f32_i32 v12, v12
    v_mov_b32 v15, s1
    v_mfma_f32_16x16x32_bf16 v[96:99], v[144:147], v[80:83], 0
    v_mfma_f32_16x16x32_bf16 v[100:103], v[148:151], v[80:83], 0
    v_mfma_f32_16x16x32_bf16 v[104:107], v[152:155], v[80:83], 0
    v_mfma_f32_16x16x32_bf16 v[108:111], v[156:159], v[80:83], 0
    v_mfma_f32_16x16x32_bf16 v[96:99], v[160:163], v[84:87], v[96:99]
    s_nop 0
    v_mov_b32 v13, v32
    s_mov_b64 exec, 0xffff
    buffer_store_dwordx4 v[12:15], v28, s[12:15], s70 offen sc1
    s_mov_b64 exec, -1
    v_mfma_f32_16x16x32_bf16 v[100:103], v[164:167], v[84:87], v[100:103]
    v_mfma_f32_16x16x32_bf16 v[104:107], v[168:171], v[84:87], v[104:107]
    v_mfma_f32_16x16x32_bf16 v[108:111], v[172:175], v[84:87], v[108:111]
    v_mfma_f32_16x16x32_bf16 v[96:99], v[176:179], v[88:91], v[96:99]
    v_mfma_f32_16x16x32_bf16 v[100:103], v[180:183], v[88:91], v[100:103]
    v_mfma_f32_16x16x32_bf16 v[104:107], v[184:187], v[88:91], v[104:107]
    v_mfma_f32_16x16x32_bf16 v[108:111], v[188:191], v[88:91], v[108:111]
    v_mfma_f32_16x16x32_bf16 v[96:99], v[192:195], v[92:95], v[96:99]
    v_mfma_f32_16x16x32_bf16 v[100:103], v[196:199], v[92:95], v[100:103]
    v_mfma_f32_16x16x32_bf16 v[104:107], v[200:203], v[92:95], v[104:107]
    v_mfma_f32_16x16x32_bf16 v[108:111], v[204:207], v[92:95], v[108:111]
    s_nop 7
    s_branch L_PVE
L_SL2:
    s_cmp_lg_u32 s64, 0
    s_cbranch_scc1 L_s2y_45
    buffer_load_dwordx4 v[240:243], v40, s[28:31], s57 offen offset:0
    buffer_load_dwordx4 v[244:247], v40, s[28:31], s57 offen offset:1152
    buffer_load_dwordx4 v[248:251], v40, s[28:31], s57 offen offset:2304
    buffer_load_dwordx4 v[252:255], v40, s[28:31], s57 offen offset:3456
    s_branch L_SL2R
L_s2y_45:
    s_cmp_ge_u32 s5, 25
    s_cbranch_scc1 L_s2h_46
    s_branch L_SL2R
L_s2h_46:
    s_branch L_SL2R
L_G2:
    s_cmp_lg_u32 s64, 0
    s_cbranch_scc1 L_GY
    v_lshlrev_b32 v16, 8, v1
    v_lshl_add_u32 v16, v2, 4, v16
    v_and_b32 v14, 3, v0
    v_lshlrev_b32 v17, 11, v14
    v_lshl_add_u32 v17, v1, 8, v17
    s_lshl_b32 s70, s59, 15
    s_lshl_b32 s68, s77, 13
    s_add_u32 s70, s70, s68
    s_add_u32 s70, s70, 1048576
    s_add_u32 s71, s70, 4096
    s_lshr_b32 s74, s6, 4
    s_lshl_b32 s74, s74, 15
    s_add_u32 s74, s74, s68
    s_and_b32 s68, s6, 15
    s_lshl_b32 s68, s68, 4
    s_add_u32 s74, s74, s68
    s_add_u32 s74, s74, 200704
    v_lshlrev_b32 v23, 9, v2
    v_lshl_add_u32 v23, v1, 4, v23
    s_lshl_b32 s68, s77, 10
    v_lshl_add_u32 v18, v11, 9, v10
    v_add_u32 v18, s68, v18
    v_lshl_add_u32 v21, v11, 8, v10
    v_lshl_add_u32 v22, v11, 10, v10
    s_lshl_b32 s68, s77, 3
    s_add_u32 s68, s68, 163584
    v_mov_b32 v19, s68
    s_lshl_b32 s68, s77, 7
    v_lshl_add_u32 v20, v1, 4, s68
    s_lshl_b32 s75, s59, 2
    s_add_u32 s75, s75, s77
    s_lshl_b32 s75, s75, 9
    s_add_u32 s75, s75, 5505024
    s_add_u32 s66, s75, 262144
    s_lshl_b32 s76, s6, 13
    s_lshl_b32 s68, s7, 7
    s_add_u32 s76, s76, s68
    s_add_u32 s76, s76, 5505024
    s_mul_i32 s69, s65, 2304
    s_lshl_b32 s68, s77, 8
    s_add_u32 s69, s69, s68
    s_add_u32 s69, s69, 266240
    s_mov_b32 s67, 0x10001
    v_mov_b32 v15, 163584
    v_and_b32 v12, 3, v2
    v_lshlrev_b32 v12, 3, v12
    v_lshrrev_b32 v12, v12, s1
    v_lshrrev_b32 v13, 2, v2
    v_sub_u32 v13, 0, v13
    v_xor_b32 v12, v12, v13
    v_bfe_u32 v68, v12, 0, 1
    v_bfe_u32 v13, v12, 1, 1
    v_lshl_or_b32 v68, v13, 16, v68
    v_bfe_u32 v69, v12, 2, 1
    v_bfe_u32 v13, v12, 3, 1
    v_lshl_or_b32 v69, v13, 16, v69
    v_bfe_u32 v70, v12, 4, 1
    v_bfe_u32 v13, v12, 5, 1
    v_lshl_or_b32 v70, v13, 16, v70
    v_bfe_u32 v71, v12, 6, 1
    v_bfe_u32 v13, v12, 7, 1
    v_lshl_or_b32 v71, v13, 16, v71
    s_setprio 0
    s_mov_b32 s72, 4000000
L_lw_47:
    ds_read_b32 v14, v8 offset:28
    s_waitcnt lgkmcnt(0)
    v_readfirstlane_b32 s73, v14
    s_cmp_ge_u32 s73, 8
    s_cbranch_scc1 L_lwd_48
    s_sub_u32 s72, s72, 1
    s_cbranch_scc0 L_lw_47
L_lwd_48:
    s_setprio 3
    s_mov_b32 s72, 400000
L_pl_49:
    buffer_load_dwordx4 v[112:115], v17, s[12:15], s74 offen sc1
    s_waitcnt vmcnt(0)
    v_cmp_ne_u32 vcc, s1, v114
    s_and_b64 exec, exec, vcc
    s_cbranch_execz L_pld_50
    s_sub_u32 s72, s72, 1
    s_cbranch_scc0 L_pl_49
L_pld_50:
    s_mov_b64 exec, -1
    v_mov_b32 v12, v112
    v_mov_b32_dpp v116, v112 quad_perm:[0,0,0,0] row_mask:0xf bank_mask:0xf
    v_mov_b32_dpp v117, v112 quad_perm:[1,1,1,1] row_mask:0xf bank_mask:0xf
    v_mov_b32_dpp v118, v112 quad_perm:[2,2,2,2] row_mask:0xf bank_mask:0xf
    v_mov_b32_dpp v119, v112 quad_perm:[3,3,3,3] row_mask:0xf bank_mask:0xf
    v_max_f32_dpp v12, v12, v12 row_ror:8 row_mask:0xf bank_mask:0xf
    s_nop 1
    v_max_f32_dpp v12, v12, v12 row_ror:2 row_mask:0xf bank_mask:0xf
    s_nop 1
    v_max_f32_dpp v12, v12, v12 row_ror:1 row_mask:0xf bank_mask:0xf
    v_mov_b32 v14, v12
    s_nop 1
    v_permlane16_swap_b32 v12, v14
    v_max_f32 v12, v12, v14
    v_mov_b32 v14, v12
    s_nop 1
    v_permlane32_swap_b32 v12, v14
    v_max_f32 v12, v12, v14
    v_sub_f32 v13, v112, v12
    v_exp_f32 v13, v13
    s_nop 0
    v_mul_f32 v13, v13, v113
    s_nop 1
    v_add_f32_dpp v13, v13, v13 row_ror:8 row_mask:0xf bank_mask:0xf
    s_nop 1
    v_add_f32_dpp v13, v13, v13 row_ror:2 row_mask:0xf bank_mask:0xf
    s_nop 1
    v_add_f32_dpp v13, v13, v13 row_ror:1 row_mask:0xf bank_mask:0xf
    v_mov_b32 v14, v13
    s_nop 1
    v_permlane16_swap_b32 v13, v14
    v_add_f32 v13, v13, v14
    v_mov_b32 v14, v13
    s_nop 1
    v_permlane32_swap_b32 v13, v14
    v_add_f32 v13, v13, v14
    s_mov_b64 exec, 1
    ds_write_b64 v19, v[12:13]
    s_mov_b64 exec, -1
    buffer_load_dwordx4 v[80:83], v16, s[12:15], s70 offen offset:0 sc1
    buffer_load_dwordx4 v[84:87], v16, s[12:15], s70 offen offset:128 sc1
    buffer_load_dwordx4 v[88:91], v16, s[12:15], s70 offen offset:2048 sc1
    buffer_load_dwordx4 v[92:95], v16, s[12:15], s70 offen offset:2176 sc1
    buffer_load_dwordx4 v[96:99], v16, s[12:15], s71 offen offset:0 sc1
    buffer_load_dwordx4 v[100:103], v16, s[12:15], s71 offen offset:128 sc1
    buffer_load_dwordx4 v[104:107], v16, s[12:15], s71 offen offset:2048 sc1
    buffer_load_dwordx4 v[108:111], v16, s[12:15], s71 offen offset:2176 sc1
    s_waitcnt lgkmcnt(0)
    s_barrier
    ds_read_b128 v[136:139], v15
    ds_read_b128 v[140:143], v15 offset:16
    s_waitcnt lgkmcnt(0)
    v_max_f32 v12, v136, v138
    v_max3_f32 v12, v12, v140, v142
    v_sub_f32 v116, v116, v12
    v_sub_f32 v117, v117, v12
    v_sub_f32 v118, v118, v12
    v_sub_f32 v119, v119, v12
    v_sub_f32 v136, v136, v12
    v_sub_f32 v138, v138, v12
    v_sub_f32 v140, v140, v12
    v_sub_f32 v142, v142, v12
    v_exp_f32 v116, v116
    v_exp_f32 v117, v117
    v_exp_f32 v118, v118
    v_exp_f32 v119, v119
    v_exp_f32 v136, v136
    v_exp_f32 v138, v138
    v_exp_f32 v140, v140
    v_exp_f32 v142, v142
    v_cvt_pk_bf16_f32 v116, v116, v116
    v_cvt_pk_bf16_f32 v117, v117, v117
    v_cvt_pk_bf16_f32 v118, v118, v118
    v_cvt_pk_bf16_f32 v119, v119, v119
    v_mul_f32 v13, v136, v137
    v_fmac_f32 v13, v138, v139
    v_fmac_f32 v13, v140, v141
    v_fmac_f32 v13, v142, v143
    v_rcp_f32 v72, v13
    v_and_b32 v120, v116, v4
    v_and_b32 v121, v116, v5
    v_and_b32 v122, v116, v6
    v_and_b32 v123, v116, v7
    v_and_b32 v124, v117, v4
    v_and_b32 v125, v117, v5
    v_and_b32 v126, v117, v6
    v_and_b32 v127, v117, v7
    v_and_b32 v128, v118, v4
    v_and_b32 v129, v118, v5
    v_and_b32 v130, v118, v6
    v_and_b32 v131, v118, v7
    v_and_b32 v132, v119, v4
    v_and_b32 v133, v119, v5
    v_and_b32 v134, v119, v6
    v_and_b32 v135, v119, v7
    s_mov_b32 s72, 400000
    s_mov_b64 s[78:79], -1
L_h3re_52:
    s_waitcnt vmcnt(7)
    v_xor_b32 v80, v68, v80
    v_xor_b32 v81, v69, v81
    v_xor_b32 v82, v70, v82
    v_xor_b32 v83, v71, v83
    s_mov_b64 exec, -1
    s_nop 0
    v_mfma_f32_16x16x32_bf16 v[48:51], v[120:123], v[80:83], 0
    s_mov_b64 exec, s[78:79]
    s_waitcnt vmcnt(6)
    v_xor_b32 v84, v68, v84
    v_xor_b32 v85, v69, v85
    v_xor_b32 v86, v70, v86
    v_xor_b32 v87, v71, v87
    v_or_b32 v12, v80, v81
    v_or_b32 v13, v82, v83
    s_mov_b64 exec, -1
    v_mfma_f32_16x16x32_bf16 v[52:55], v[120:123], v[84:87], 0
    s_mov_b64 exec, s[78:79]
    s_waitcnt vmcnt(5)
    v_xor_b32 v88, v68, v88
    v_xor_b32 v89, v69, v89
    v_xor_b32 v90, v70, v90
    v_xor_b32 v91, v71, v91
    v_or3_b32 v12, v12, v84, v85
    v_or3_b32 v13, v13, v86, v87
    s_mov_b64 exec, -1
    v_mfma_f32_16x16x32_bf16 v[48:51], v[124:127], v[88:91], v[48:51]
    s_mov_b64 exec, s[78:79]
    s_waitcnt vmcnt(4)
    v_xor_b32 v92, v68, v92
    v_xor_b32 v93, v69, v93
    v_xor_b32 v94, v70, v94
    v_xor_b32 v95, v71, v95
    v_or3_b32 v12, v12, v88, v89
    v_or3_b32 v13, v13, v90, v91
    s_mov_b64 exec, -1
    v_mfma_f32_16x16x32_bf16 v[52:55], v[124:127], v[92:95], v[52:55]
    s_mov_b64 exec, s[78:79]
    s_waitcnt vmcnt(3)
    v_xor_b32 v96, v68, v96
    v_xor_b32 v97, v69, v97
    v_xor_b32 v98, v70, v98
    v_xor_b32 v99, v71, v99
    v_or3_b32 v12, v12, v92, v93
    v_or3_b32 v13, v13, v94, v95
    s_mov_b64 exec, -1
    v_mfma_f32_16x16x32_bf16 v[48:51], v[128:131], v[96:99], v[48:51]
    s_mov_b64 exec, s[78:79]
    s_waitcnt vmcnt(2)
    v_xor_b32 v100, v68, v100
    v_xor_b32 v101, v69, v101
    v_xor_b32 v102, v70, v102
    v_xor_b32 v103, v71, v103
    v_or3_b32 v12, v12, v96, v97
    v_or3_b32 v13, v13, v98, v99
    s_mov_b64 exec, -1
    v_mfma_f32_16x16x32_bf16 v[52:55], v[128:131], v[100:103], v[52:55]
    s_mov_b64 exec, s[78:79]
    s_waitcnt vmcnt(1)
    v_xor_b32 v104, v68, v104
    v_xor_b32 v105, v69, v105
    v_xor_b32 v106, v70, v106
    v_xor_b32 v107, v71, v107
    v_or3_b32 v12, v12, v100, v101
    v_or3_b32 v13, v13, v102, v103
    s_mov_b64 exec, -1
    v_mfma_f32_16x16x32_bf16 v[48:51], v[132:135], v[104:107], v[48:51]
    s_mov_b64 exec, s[78:79]
    s_waitcnt vmcnt(0)
    v_xor_b32 v108, v68, v108
    v_xor_b32 v109, v69, v109
    v_xor_b32 v110, v70, v110
    v_xor_b32 v111, v71, v111
    v_or3_b32 v12, v12, v104, v105
    v_or3_b32 v13, v13, v106, v107
    s_mov_b64 exec, -1
    v_mfma_f32_16x16x32_bf16 v[52:55], v[132:135], v[108:111], v[52:55]
    s_mov_b64 exec, s[78:79]
    v_or3_b32 v12, v12, v108, v109
    v_or3_b32 v13, v13, v110, v111
    v_or_b32 v12, v12, v13
    v_and_b32 v12, s67, v12
    s_nop 1
    v_or_b32_dpp v12, v12, v12 quad_perm:[1,0,3,2] row_mask:0xf bank_mask:0xf
    s_nop 1
    v_or_b32_dpp v12, v12, v12 quad_perm:[2,3,0,1] row_mask:0xf bank_mask:0xf
    s_nop 1
    v_or_b32_dpp v12, v12, v12 row_half_mirror row_mask:0xf bank_mask:0xf
    v_cmp_ne_u32 vcc, 0, v12
    s_cbranch_vccz L_h3ok_51
    s_mov_b64 s[78:79], vcc
    s_mov_b64 exec, vcc
    buffer_load_dwordx4 v[80:83], v16, s[12:15], s70 offen offset:0 sc1
    buffer_load_dwordx4 v[84:87], v16, s[12:15], s70 offen offset:128 sc1
    buffer_load_dwordx4 v[88:91], v16, s[12:15], s70 offen offset:2048 sc1
    buffer_load_dwordx4 v[92:95], v16, s[12:15], s70 offen offset:2176 sc1
    buffer_load_dwordx4 v[96:99], v16, s[12:15], s71 offen offset:0 sc1
    buffer_load_dwordx4 v[100:103], v16, s[12:15], s71 offen offset:128 sc1
    buffer_load_dwordx4 v[104:107], v16, s[12:15], s71 offen offset:2048 sc1
    buffer_load_dwordx4 v[108:111], v16, s[12:15], s71 offen offset:2176 sc1
    s_sub_u32 s72, s72, 1
    s_cbranch_scc0 L_h3re_52
    s_waitcnt vmcnt(0)
L_h3ok_51:
    s_mov_b32 exec_lo, 0x00ff00ff
    s_mov_b32 exec_hi, 0xff00ff00
    ds_write_b128 v18, v[48:51]
    ds_write_b128 v18, v[52:55] offset:256
    s_mov_b64 exec, -1
    buffer_load_dwordx4 v[144:147], v40, s[28:31], s57 offen offset:512
    buffer_load_dwordx4 v[148:151], v40, s[28:31], s57 offen offset:1664
    buffer_load_dwordx4 v[152:155], v40, s[28:31], s57 offen offset:2816
    buffer_load_dwordx4 v[156:159], v40, s[28:31], s57 offen offset:3968
    s_cmp_lg_u32 s77, 0
    s_cbranch_scc1 L_w3_53
    s_add_u32 s57, s57, 1024
    buffer_load_dwordx4 v[160:163], v40, s[28:31], s57 offen offset:0
    buffer_load_dwordx4 v[164:167], v40, s[28:31], s57 offen offset:1152
    buffer_load_dwordx4 v[168:171], v40, s[28:31], s57 offen offset:2304
    buffer_load_dwordx4 v[172:175], v40, s[28:31], s57 offen offset:3456
L_w3_53:
    s_waitcnt lgkmcnt(0)
    s_barrier
    ds_read_b128 v[80:83], v20 offset:0
    ds_read_b128 v[84:87], v20 offset:512
    ds_read_b128 v[88:91], v20 offset:1024
    ds_read_b128 v[92:95], v20 offset:1536
    ds_read_b128 v[96:99], v20 offset:2048
    ds_read_b128 v[100:103], v20 offset:2560
    ds_read_b128 v[104:107], v20 offset:3072
    ds_read_b128 v[108:111], v20 offset:3584
    s_waitcnt lgkmcnt(6)
    v_pk_add_f32 v[80:81], v[80:81], v[84:85]
    v_pk_add_f32 v[82:83], v[82:83], v[86:87]
    s_waitcnt lgkmcnt(4)
    v_pk_add_f32 v[88:89], v[88:89], v[92:93]
    v_pk_add_f32 v[90:91], v[90:91], v[94:95]
    s_waitcnt lgkmcnt(2)
    v_pk_add_f32 v[96:97], v[96:97], v[100:101]
    v_pk_add_f32 v[98:99], v[98:99], v[102:103]
    s_waitcnt lgkmcnt(0)
    v_pk_add_f32 v[104:105], v[104:105], v[108:109]
    v_pk_add_f32 v[106:107], v[106:107], v[110:111]
    v_pk_add_f32 v[80:81], v[80:81], v[88:89]
    v_pk_add_f32 v[82:83], v[82:83], v[90:91]
    v_pk_add_f32 v[96:97], v[96:97], v[104:105]
    v_pk_add_f32 v[98:99], v[98:99], v[106:107]
    v_pk_add_f32 v[80:81], v[80:81], v[96:97]
    v_pk_add_f32 v[82:83], v[82:83], v[98:99]
    v_mul_f32 v80, v80, v72
    v_cvt_pk_bf16_f32 v80, v80, v80
    v_and_b32 v120, v80, v4
    v_and_b32 v121, v80, v5
    v_and_b32 v122, v80, v6
    v_and_b32 v123, v80, v7
    v_mul_f32 v81, v81, v72
    v_cvt_pk_bf16_f32 v81, v81, v81
    v_and_b32 v124, v81, v4
    v_and_b32 v125, v81, v5
    v_and_b32 v126, v81, v6
    v_and_b32 v127, v81, v7
    v_mfma_f32_16x16x32_bf16 v[48:51], v[120:123], v[208:211], 0
    v_mfma_f32_16x16x32_bf16 v[52:55], v[120:123], v[212:215], 0
    v_mul_f32 v82, v82, v72
    v_cvt_pk_bf16_f32 v82, v82, v82
    v_and_b32 v128, v82, v4
    v_and_b32 v129, v82, v5
    v_and_b32 v130, v82, v6
    v_and_b32 v131, v82, v7
    v_mfma_f32_16x16x32_bf16 v[48:51], v[124:127], v[216:219], v[48:51]
    v_mfma_f32_16x16x32_bf16 v[52:55], v[124:127], v[220:223], v[52:55]
    v_mul_f32 v83, v83, v72
    v_cvt_pk_bf16_f32 v83, v83, v83
    v_and_b32 v132, v83, v4
    v_and_b32 v133, v83, v5
    v_and_b32 v134, v83, v6
    v_and_b32 v135, v83, v7
    v_mfma_f32_16x16x32_bf16 v[48:51], v[128:131], v[224:227], v[48:51]
    v_mfma_f32_16x16x32_bf16 v[52:55], v[128:131], v[228:231], v[52:55]
    v_mfma_f32_16x16x32_bf16 v[48:51], v[132:135], v[232:235], v[48:51]
    v_mfma_f32_16x16x32_bf16 v[52:55], v[132:135], v[236:239], v[52:55]
    s_add_u32 s67, s76, 262144
    s_add_u32 s70, s67, 4096
    s_mov_b32 s72, 8
    s_nop 4
    v_permlane32_swap_b32 v48, v52
    v_permlane32_swap_b32 v49, v53
    v_permlane32_swap_b32 v50, v54
    v_permlane32_swap_b32 v51, v55
    v_add_f32_dpp v48, v52, v48 row_ror:8 row_mask:0xf bank_mask:0xf
    v_add_f32_dpp v49, v53, v49 row_ror:8 row_mask:0xf bank_mask:0xf
    v_add_f32_dpp v50, v54, v50 row_ror:8 row_mask:0xf bank_mask:0xf
    v_add_f32_dpp v51, v55, v51 row_ror:8 row_mask:0xf bank_mask:0xf
    s_mov_b32 exec_lo, 0x00ff00ff
    s_mov_b32 exec_hi, 0x00ff00ff
    buffer_store_dwordx4 v[48:51], v21, s[12:15], s66 offen
    s_mov_b64 exec, -1
L_h4a_54:
    buffer_load_dwordx4 v[80:83], v23, s[12:15], s67 offen sc1
    buffer_load_dwordx4 v[84:87], v23, s[12:15], s70 offen sc1
    s_waitcnt vmcnt(0)
    v_max_u32 v12, v80, v84
    v_cmp_eq_u32 vcc, -1, v12
    s_and_b64 exec, exec, vcc
    s_cbranch_execz L_h4b_55
    s_sub_u32 s72, s72, 1
    s_cbranch_scc0 L_h4a_54
L_h4b_55:
    s_mov_b64 s[78:79], exec
    s_mov_b32 exec_lo, 0x00ff00ff
    s_mov_b32 exec_hi, 0x00ff00ff
    buffer_store_dwordx4 v[48:51], v21, s[12:15], s75 offen sc1
    s_mov_b64 exec, s[78:79]
    s_cbranch_execz L_h4c_56
    s_xor_b32 s67, s67, s76
    s_mov_b32 s72, 400000
L_pl_57:
    s_add_u32 s70, s76, 4096
    buffer_load_dwordx4 v[80:83], v23, s[12:15], s76 offen sc1
    buffer_load_dwordx4 v[84:87], v23, s[12:15], s70 offen sc1
    s_xor_b32 s76, s76, s67
    s_waitcnt vmcnt(0)
    v_max_u32 v12, v80, v84
    v_cmp_eq_u32 vcc, -1, v12
    s_and_b64 exec, exec, vcc
    s_cbranch_execz L_pld_58
    s_sub_u32 s72, s72, 1
    s_cbranch_scc0 L_pl_57
L_pld_58:
    s_mov_b64 exec, -1
L_h4c_56:
    s_mov_b64 exec, -1
    v_pk_add_f32 v[80:81], v[80:81], v[84:85]
    v_pk_add_f32 v[82:83], v[82:83], v[86:87]
    s_nop 0
    v_add_f32_dpp v80, v80, v80 quad_perm:[1,0,3,2] row_mask:0xf bank_mask:0xf
    v_add_f32_dpp v81, v81, v81 quad_perm:[1,0,3,2] row_mask:0xf bank_mask:0xf
    v_add_f32_dpp v82, v82, v82 quad_perm:[1,0,3,2] row_mask:0xf bank_mask:0xf
    v_add_f32_dpp v83, v83, v83 quad_perm:[1,0,3,2] row_mask:0xf bank_mask:0xf
    v_add_f32_dpp v80, v80, v80 quad_perm:[2,3,0,1] row_mask:0xf bank_mask:0xf
    v_add_f32_dpp v81, v81, v81 quad_perm:[2,3,0,1] row_mask:0xf bank_mask:0xf
    v_add_f32_dpp v82, v82, v82 quad_perm:[2,3,0,1] row_mask:0xf bank_mask:0xf
    v_add_f32_dpp v83, v83, v83 quad_perm:[2,3,0,1] row_mask:0xf bank_mask:0xf
    v_add_f32_dpp v80, v80, v80 row_half_mirror row_mask:0xf bank_mask:0xf
    v_add_f32_dpp v81, v81, v81 row_half_mirror row_mask:0xf bank_mask:0xf
    v_add_f32_dpp v82, v82, v82 row_half_mirror row_mask:0xf bank_mask:0xf
    v_add_f32_dpp v83, v83, v83 row_half_mirror row_mask:0xf bank_mask:0xf
    v_cvt_pk_bf16_f32 v80, v80, v80
    v_and_b32 v120, v80, v4
    v_and_b32 v121, v80, v5
    v_and_b32 v122, v80, v6
    v_and_b32 v123, v80, v7
    v_cvt_pk_bf16_f32 v81, v81, v81
    v_and_b32 v124, v81, v4
    v_and_b32 v125, v81, v5
    v_and_b32 v126, v81, v6
    v_and_b32 v127, v81, v7
    v_mfma_f32_16x16x32_bf16 v[56:59], v[120:123], v[240:243], 0
    v_mfma_f32_16x16x32_bf16 v[60:63], v[120:123], v[144:147], 0
    v_cvt_pk_bf16_f32 v82, v82, v82
    v_and_b32 v128, v82, v4
    v_and_b32 v129, v82, v5
    v_and_b32 v130, v82, v6
    v_and_b32 v131, v82, v7
    v_mfma_f32_16x16x32_bf16 v[56:59], v[124:127], v[244:247], v[56:59]
    v_mfma_f32_16x16x32_bf16 v[60:63], v[124:127], v[148:151], v[60:63]
    v_cvt_pk_bf16_f32 v83, v83, v83
    v_and_b32 v132, v83, v4
    v_and_b32 v133, v83, v5
    v_and_b32 v134, v83, v6
    v_and_b32 v135, v83, v7
    v_mfma_f32_16x16x32_bf16 v[56:59], v[128:131], v[248:251], v[56:59]
    v_mfma_f32_16x16x32_bf16 v[60:63], v[128:131], v[152:155], v[60:63]
    v_mfma_f32_16x16x32_bf16 v[56:59], v[132:135], v[252:255], v[56:59]
    v_mfma_f32_16x16x32_bf16 v[60:63], v[132:135], v[156:159], v[60:63]
    s_cmp_lg_u32 s77, 0
    s_cbranch_scc1 L_s3_59
    v_mfma_f32_16x16x32_bf16 v[64:67], v[120:123], v[160:163], 0
    v_mfma_f32_16x16x32_bf16 v[64:67], v[124:127], v[164:167], v[64:67]
    v_mfma_f32_16x16x32_bf16 v[64:67], v[128:131], v[168:171], v[64:67]
    v_mfma_f32_16x16x32_bf16 v[64:67], v[132:135], v[172:175], v[64:67]
L_s3_59:
    s_nop 5
    v_permlane32_swap_b32 v56, v60
    v_permlane32_swap_b32 v57, v61
    v_permlane32_swap_b32 v58, v62
    v_permlane32_swap_b32 v59, v63
    v_add_f32_dpp v56, v60, v56 row_ror:8 row_mask:0xf bank_mask:0xf
    v_add_f32_dpp v57, v61, v57 row_ror:8 row_mask:0xf bank_mask:0xf
    v_add_f32_dpp v58, v62, v58 row_ror:8 row_mask:0xf bank_mask:0xf
    v_add_f32_dpp v59, v63, v59 row_ror:8 row_mask:0xf bank_mask:0xf
    v_bfi_b32 v56, v43, s60, v56
    v_bfi_b32 v57, v43, s61, v57
    v_bfi_b32 v58, v43, s62, v58
    v_bfi_b32 v59, v43, s63, v59
    s_mov_b32 exec_lo, 0x00ff00ff
    s_mov_b32 exec_hi, 0x00ff00ff
    buffer_store_dwordx4 v[56:59], v22, s[12:15], s69 offen sc1
    s_cmp_lg_u32 s77, 0
    s_cbranch_scc1 L_pt_60
    s_mov_b64 exec, -1
    v_mov_b32 v60, v64
    v_mov_b32 v61, v65
    v_mov_b32 v62, v66
    v_mov_b32 v63, v67
    v_permlane32_swap_b32 v64, v60
    v_permlane32_swap_b32 v65, v61
    v_permlane32_swap_b32 v66, v62
    v_permlane32_swap_b32 v67, v63
    v_add_f32_dpp v64, v60, v64 row_ror:8 row_mask:0xf bank_mask:0xf
    v_add_f32_dpp v65, v61, v65 row_ror:8 row_mask:0xf bank_mask:0xf
    v_add_f32_dpp v66, v62, v66 row_ror:8 row_mask:0xf bank_mask:0xf
    v_add_f32_dpp v67, v63, v67 row_ror:8 row_mask:0xf bank_mask:0xf
    v_bfi_b32 v64, v43, s60, v64
    v_bfi_b32 v65, v43, s61, v65
    v_bfi_b32 v66, v43, s62, v66
    v_bfi_b32 v67, v43, s63, v67
    s_mov_b32 exec_lo, 0x00ff00ff
    s_mov_b32 exec_hi, 0x00000000
    buffer_store_dwordx4 v[64:67], v22, s[12:15], s69 offen offset:2048 sc1
L_pt_60:
    s_mov_b64 exec, -1
    s_mov_b64 exec, 1
    ds_add_u32 v8, v9 offset:32
    s_mov_b64 exec, -1
    s_branch L_Gend
L_GY:
    s_setprio 0
    s_cmp_lt_u32 s5, 25
    s_cbranch_scc1 L_GF
    s_mov_b32 s72, 4000000
L_lw_62:
    ds_read_b32 v12, v8 offset:28
    s_waitcnt lgkmcnt(0)
    v_readfirstlane_b32 s73, v12
    s_cmp_ge_u32 s73, 8
    s_cbranch_scc1 L_lwd_63
    s_sub_u32 s72, s72, 1
    s_cbranch_scc0 L_lw_62
L_lwd_63:
L_hp_61:
    s_mul_i32 s68, s56, 73728
    s_lshl_b32 s69, s57, 10
    s_add_u32 s68, s68, s69
    s_add_u32 s68, s68, s59
    buffer_load_dwordx4 v[208:211], v3, s[36:39], s68 offen
    s_add_u32 s56, s56, 1
    s_cmp_eq_u32 s56, 9
    s_cselect_b32 s56, 0, s56
    s_addc_u32 s57, s57, 3
    s_cmp_lt_u32 s57, 72
    s_cbranch_scc1 L_hp_61
    s_branch L_Gend
L_GF:
    s_mul_i32 s68, s77, 576
    s_add_u32 s68, s68, 153600
    v_mul_u32_u24 v12, 72, v1
    v_add_u32 v12, s68, v12
    ds_read_b64 v[48:49], v12 offset:0
    ds_read_b64 v[50:51], v12 offset:8
    ds_read_b64 v[52:53], v12 offset:16
    ds_read_b64 v[54:55], v12 offset:24
    ds_read_b64 v[56:57], v12 offset:32
    ds_read_b64 v[58:59], v12 offset:40
    ds_read_b64 v[60:61], v12 offset:48
    ds_read_b64 v[62:63], v12 offset:56
    ds_read_b64 v[64:65], v12 offset:64
    v_mul_u32_u24 v18, 9216, v1
    v_lshl_add_u32 v18, v2, 4, v18
    s_mul_i32 s70, s66, 73728
    s_lshl_b32 s68, s77, 7
    s_add_u32 s70, s70, s68
    s_add_u32 s74, s70, 3456
    s_add_u32 s75, s70, 6912
    s_mov_b32 s72, 4000000
L_lw_64:
    ds_read_b32 v12, v8 offset:28
    s_waitcnt lgkmcnt(0)
    v_readfirstlane_b32 s73, v12
    s_cmp_ge_u32 s73, 8
    s_cbranch_scc1 L_lwd_65
    s_sub_u32 s72, s72, 1
    s_cbranch_scc0 L_lw_64
L_lwd_65:
    buffer_load_dwordx4 v[240:243], v40, s[32:35], s56 offen
    s_add_u32 s56, s56, 9216
    buffer_load_dwordx4 v[244:247], v40, s[32:35], s56 offen
    s_add_u32 s56, s56, 9216
    buffer_load_dwordx4 v[248:251], v40, s[32:35], s56 offen
    s_add_u32 s56, s56, 9216
    buffer_load_dwordx4 v[252:255], v40, s[32:35], s56 offen
    s_add_u32 s56, s56, 9216
    buffer_load_dwordx4 v[176:179], v40, s[32:35], s56 offen
    s_add_u32 s56, s56, 9216
    buffer_load_dwordx4 v[180:183], v40, s[32:35], s56 offen
    s_add_u32 s56, s56, 9216
    buffer_load_dwordx4 v[184:187], v40, s[32:35], s56 offen
    s_add_u32 s56, s56, 9216
    buffer_load_dwordx4 v[188:191], v40, s[32:35], s56 offen
    s_add_u32 s56, s56, 9216
    buffer_load_dwordx4 v[192:195], v40, s[32:35], s56 offen
    s_add_u32 s56, s56, 9216
    buffer_load_dwordx4 v[196:199], v40, s[32:35], s56 offen
    buffer_load_dwordx4 v[80:83], v18, s[36:39], s70 offen offset:0
    buffer_load_dwordx4 v[84:87], v18, s[36:39], s70 offen offset:512
    s_lshl_b32 s68, s77, 9
    s_add_u32 s68, s68, 160256
    v_lshl_add_u32 v16, v11, 8, v10
    v_add_u32 v16, s68, v16
    v_add_u32 v17, 160256, v42
    v_lshlrev_b32 v20, 5, v1
    v_add_u32 v20, 163328, v20
    v_lshl_add_u32 v19, v11, 10, v10
    s_mul_i32 s76, s66, 2304
    s_lshl_b32 s68, s77, 8
    s_add_u32 s76, s76, s68
    s_add_u32 s76, s76, 561152
    v_and_b32 v68, v48, v4
    v_and_b32 v69, v48, v5
    v_and_b32 v70, v48, v6
    v_and_b32 v71, v48, v7
    s_waitcnt vmcnt(12)
    s_nop 0
    v_mfma_f32_16x16x32_bf16 v[76:79], v[68:71], v[208:211], 0
    v_and_b32 v72, v49, v4
    v_and_b32 v73, v49, v5
    v_and_b32 v74, v49, v6
    v_and_b32 v75, v49, v7
    s_waitcnt vmcnt(12)
    s_nop 0
    v_mfma_f32_16x16x32_bf16 v[76:79], v[72:75], v[212:215], v[76:79]
    v_and_b32 v68, v50, v4
    v_and_b32 v69, v50, v5
    v_and_b32 v70, v50, v6
    v_and_b32 v71, v50, v7
    s_waitcnt vmcnt(12)
    s_nop 0
    v_mfma_f32_16x16x32_bf16 v[76:79], v[68:71], v[216:219], v[76:79]
    v_and_b32 v72, v51, v4
    v_and_b32 v73, v51, v5
    v_and_b32 v74, v51, v6
    v_and_b32 v75, v51, v7
    s_waitcnt vmcnt(12)
    s_nop 0
    v_mfma_f32_16x16x32_bf16 v[76:79], v[72:75], v[220:223], v[76:79]
    v_and_b32 v68, v52, v4
    v_and_b32 v69, v52, v5
    v_and_b32 v70, v52, v6
    v_and_b32 v71, v52, v7
    s_waitcnt vmcnt(12)
    s_nop 0
    v_mfma_f32_16x16x32_bf16 v[76:79], v[68:71], v[224:227], v[76:79]
    v_and_b32 v72, v53, v4
    v_and_b32 v73, v53, v5
    v_and_b32 v74, v53, v6
    v_and_b32 v75, v53, v7
    s_waitcnt vmcnt(12)
    s_nop 0
    v_mfma_f32_16x16x32_bf16 v[76:79], v[72:75], v[228:231], v[76:79]
    v_and_b32 v68, v54, v4
    v_and_b32 v69, v54, v5
    v_and_b32 v70, v54, v6
    v_and_b32 v71, v54, v7
    s_waitcnt vmcnt(12)
    s_nop 0
    v_mfma_f32_16x16x32_bf16 v[76:79], v[68:71], v[232:235], v[76:79]
    v_and_b32 v72, v55, v4
    v_and_b32 v73, v55, v5
    v_and_b32 v74, v55, v6
    v_and_b32 v75, v55, v7
    s_waitcnt vmcnt(12)
    s_nop 0
    v_mfma_f32_16x16x32_bf16 v[76:79], v[72:75], v[236:239], v[76:79]
    v_and_b32 v68, v56, v4
    v_and_b32 v69, v56, v5
    v_and_b32 v70, v56, v6
    v_and_b32 v71, v56, v7
    s_waitcnt vmcnt(11)
    s_nop 0
    v_mfma_f32_16x16x32_bf16 v[76:79], v[68:71], v[240:243], v[76:79]
    v_and_b32 v72, v57, v4
    v_and_b32 v73, v57, v5
    v_and_b32 v74, v57, v6
    v_and_b32 v75, v57, v7
    s_waitcnt vmcnt(10)
    s_nop 0
    v_mfma_f32_16x16x32_bf16 v[76:79], v[72:75], v[244:247], v[76:79]
    v_and_b32 v68, v58, v4
    v_and_b32 v69, v58, v5
    v_and_b32 v70, v58, v6
    v_and_b32 v71, v58, v7
    s_waitcnt vmcnt(9)
    s_nop 0
    v_mfma_f32_16x16x32_bf16 v[76:79], v[68:71], v[248:251], v[76:79]
    v_and_b32 v72, v59, v4
    v_and_b32 v73, v59, v5
    v_and_b32 v74, v59, v6
    v_and_b32 v75, v59, v7
    s_waitcnt vmcnt(8)
    s_nop 0
    v_mfma_f32_16x16x32_bf16 v[76:79], v[72:75], v[252:255], v[76:79]
    v_and_b32 v68, v60, v4
    v_and_b32 v69, v60, v5
    v_and_b32 v70, v60, v6
    v_and_b32 v71, v60, v7
    s_waitcnt vmcnt(7)
    s_nop 0
    v_mfma_f32_16x16x32_bf16 v[76:79], v[68:71], v[176:179], v[76:79]
    buffer_load_dwordx4 v[88:91], v18, s[36:39], s70 offen offset:1152
    v_and_b32 v72, v61, v4
    v_and_b32 v73, v61, v5
    v_and_b32 v74, v61, v6
    v_and_b32 v75, v61, v7
    s_waitcnt vmcnt(7)
    s_nop 0
    v_mfma_f32_16x16x32_bf16 v[76:79], v[72:75], v[180:183], v[76:79]
    buffer_load_dwordx4 v[92:95], v18, s[36:39], s70 offen offset:1664
    v_and_b32 v68, v62, v4
    v_and_b32 v69, v62, v5
    v_and_b32 v70, v62, v6
    v_and_b32 v71, v62, v7
    s_waitcnt vmcnt(7)
    s_nop 0
    v_mfma_f32_16x16x32_bf16 v[76:79], v[68:71], v[184:187], v[76:79]
    buffer_load_dwordx4 v[96:99], v18, s[36:39], s70 offen offset:2304
    v_and_b32 v72, v63, v4
    v_and_b32 v73, v63, v5
    v_and_b32 v74, v63, v6
    v_and_b32 v75, v63, v7
    s_waitcnt vmcnt(7)
    s_nop 0
    v_mfma_f32_16x16x32_bf16 v[76:79], v[72:75], v[188:191], v[76:79]
    buffer_load_dwordx4 v[100:103], v18, s[36:39], s70 offen offset:2816
    v_and_b32 v68, v64, v4
    v_and_b32 v69, v64, v5
    v_and_b32 v70, v64, v6
    v_and_b32 v71, v64, v7
    s_waitcnt vmcnt(7)
    s_nop 0
    v_mfma_f32_16x16x32_bf16 v[76:79], v[68:71], v[192:195], v[76:79]
    buffer_load_dwordx4 v[104:107], v18, s[36:39], s74 offen offset:0
    v_and_b32 v72, v65, v4
    v_and_b32 v73, v65, v5
    v_and_b32 v74, v65, v6
    v_and_b32 v75, v65, v7
    s_waitcnt vmcnt(7)
    s_nop 0
    v_mfma_f32_16x16x32_bf16 v[76:79], v[72:75], v[196:199], v[76:79]
    buffer_load_dwordx4 v[108:111], v18, s[36:39], s74 offen offset:512
    s_mov_b32 exec_lo, 0x00ff00ff
    s_mov_b32 exec_hi, 0xff00ff00
    s_nop 4
    ds_write_b128 v16, v[76:79]
    s_mov_b64 exec, 1
    ds_add_u32 v8, v9 offset:36
    s_mov_b64 exec, -1
    s_cmp_lg_u32 s77, 0
    s_cbranch_scc1 L_y3_66
    buffer_load_dwordx4 v[208:211], v18, s[36:39], s70 offen offset:1024
    buffer_load_dwordx4 v[212:215], v18, s[36:39], s70 offen offset:2176
    buffer_load_dwordx4 v[216:219], v18, s[36:39], s70 offen offset:3328
    buffer_load_dwordx4 v[220:223], v18, s[36:39], s74 offen offset:1024
    buffer_load_dwordx4 v[224:227], v18, s[36:39], s74 offen offset:2176
    buffer_load_dwordx4 v[228:231], v18, s[36:39], s74 offen offset:3328
    buffer_load_dwordx4 v[232:235], v18, s[36:39], s75 offen offset:1024
    buffer_load_dwordx4 v[236:239], v18, s[36:39], s75 offen offset:2176
L_y3_66:
    buffer_load_dwordx4 v[112:115], v18, s[36:39], s74 offen offset:1152
    buffer_load_dwordx4 v[116:119], v18, s[36:39], s74 offen offset:1664
    buffer_load_dwordx4 v[120:123], v18, s[36:39], s74 offen offset:2304
    buffer_load_dwordx4 v[124:127], v18, s[36:39], s74 offen offset:2816
    buffer_load_dwordx4 v[128:131], v18, s[36:39], s75 offen offset:0
    buffer_load_dwordx4 v[132:135], v18, s[36:39], s75 offen offset:512
    buffer_load_dwordx4 v[136:139], v18, s[36:39], s75 offen offset:1152
    buffer_load_dwordx4 v[140:143], v18, s[36:39], s75 offen offset:1664
    v_lshlrev_b32 v41, 16, v41
    v_add_u32 v14, 163328, v42
    s_mov_b32 s72, 4000000
L_lw_68:
    ds_read_b32 v12, v8 offset:36
    s_waitcnt lgkmcnt(0)
    v_readfirstlane_b32 s73, v12
    s_cmp_ge_u32 s73, 4
    s_cbranch_scc1 L_lwd_69
    s_sub_u32 s72, s72, 1
    s_cbranch_scc0 L_lw_68
L_lwd_69:
    ds_read2st64_b32 v[48:49], v17 offset0:0 offset1:1
    ds_read2st64_b32 v[50:51], v17 offset0:2 offset1:3
    ds_read2st64_b32 v[52:53], v17 offset0:4 offset1:5
    ds_read2st64_b32 v[54:55], v17 offset0:6 offset1:7
    s_waitcnt lgkmcnt(2)
    v_pk_add_f32 v[48:49], v[48:49], v[50:51]
    s_waitcnt lgkmcnt(0)
    v_pk_add_f32 v[52:53], v[52:53], v[54:55]
    v_pk_add_f32 v[48:49], v[48:49], v[52:53]
    v_add_f32 v48, v48, v49
    v_cvt_pk_bf16_f32 v48, v48, v48
    v_and_b32 v48, 0xffff0000, v48
    v_add_f32 v48, v48, v41
    v_cvt_pk_bf16_f32 v48, v48, v48
    v_and_b32 v48, 0xffff0000, v48
    v_mul_f32 v49, v48, v48
    v_mov_b32 v50, 0xc0135761
    v_fmac_f32 v50, 0xbdd2d3e8, v49
    v_mul_f32 v50, v50, v48
    v_exp_f32 v50, v50
    s_nop 0
    v_add_f32 v50, 1.0, v50
    v_rcp_f32 v50, v50
    s_nop 0
    v_mul_f32 v48, v48, v50
    v_cvt_pk_bf16_f32 v48, v48, v48
    ds_write_b32 v14, v48
    ds_read_b128 v[48:51], v20
    ds_read_b128 v[52:55], v20 offset:16
    s_waitcnt lgkmcnt(0)
    v_and_b32 v144, v48, v4
    v_and_b32 v145, v48, v5
    v_and_b32 v146, v48, v6
    v_and_b32 v147, v48, v7
    s_waitcnt vmcnt(15)
    s_nop 0
    v_mfma_f32_16x16x32_bf16 v[56:59], v[144:147], v[80:83], 0
    s_waitcnt vmcnt(14)
    v_mfma_f32_16x16x32_bf16 v[60:63], v[144:147], v[84:87], 0
    v_and_b32 v148, v49, v4
    v_and_b32 v149, v49, v5
    v_and_b32 v150, v49, v6
    v_and_b32 v151, v49, v7
    s_waitcnt vmcnt(13)
    s_nop 0
    v_mfma_f32_16x16x32_bf16 v[56:59], v[148:151], v[88:91], v[56:59]
    s_waitcnt vmcnt(12)
    v_mfma_f32_16x16x32_bf16 v[60:63], v[148:151], v[92:95], v[60:63]
    v_and_b32 v152, v50, v4
    v_and_b32 v153, v50, v5
    v_and_b32 v154, v50, v6
    v_and_b32 v155, v50, v7
    s_waitcnt vmcnt(11)
    s_nop 0
    v_mfma_f32_16x16x32_bf16 v[56:59], v[152:155], v[96:99], v[56:59]
    s_waitcnt vmcnt(10)
    v_mfma_f32_16x16x32_bf16 v[60:63], v[152:155], v[100:103], v[60:63]
    v_and_b32 v156, v51, v4
    v_and_b32 v157, v51, v5
    v_and_b32 v158, v51, v6
    v_and_b32 v159, v51, v7
    s_waitcnt vmcnt(9)
    s_nop 0
    v_mfma_f32_16x16x32_bf16 v[56:59], v[156:159], v[104:107], v[56:59]
    s_waitcnt vmcnt(8)
    v_mfma_f32_16x16x32_bf16 v[60:63], v[156:159], v[108:111], v[60:63]
    v_and_b32 v160, v52, v4
    v_and_b32 v161, v52, v5
    v_and_b32 v162, v52, v6
    v_and_b32 v163, v52, v7
    s_waitcnt vmcnt(7)
    s_nop 0
    v_mfma_f32_16x16x32_bf16 v[56:59], v[160:163], v[112:115], v[56:59]
    s_waitcnt vmcnt(6)
    v_mfma_f32_16x16x32_bf16 v[60:63], v[160:163], v[116:119], v[60:63]
    v_and_b32 v164, v53, v4
    v_and_b32 v165, v53, v5
    v_and_b32 v166, v53, v6
    v_and_b32 v167, v53, v7
    s_waitcnt vmcnt(5)
    s_nop 0
    v_mfma_f32_16x16x32_bf16 v[56:59], v[164:167], v[120:123], v[56:59]
    s_waitcnt vmcnt(4)
    v_mfma_f32_16x16x32_bf16 v[60:63], v[164:167], v[124:127], v[60:63]
    v_and_b32 v168, v54, v4
    v_and_b32 v169, v54, v5
    v_and_b32 v170, v54, v6
    v_and_b32 v171, v54, v7
    s_waitcnt vmcnt(3)
    s_nop 0
    v_mfma_f32_16x16x32_bf16 v[56:59], v[168:171], v[128:131], v[56:59]
    s_waitcnt vmcnt(2)
    v_mfma_f32_16x16x32_bf16 v[60:63], v[168:171], v[132:135], v[60:63]
    v_and_b32 v172, v55, v4
    v_and_b32 v173, v55, v5
    v_and_b32 v174, v55, v6
    v_and_b32 v175, v55, v7
    s_waitcnt vmcnt(1)
    s_nop 0
    v_mfma_f32_16x16x32_bf16 v[56:59], v[172:175], v[136:139], v[56:59]
    s_waitcnt vmcnt(0)
    v_mfma_f32_16x16x32_bf16 v[60:63], v[172:175], v[140:143], v[60:63]
    s_cmp_lg_u32 s77, 0
    s_cbranch_scc1 L_y4_67
    v_mfma_f32_16x16x32_bf16 v[64:67], v[144:147], v[208:211], 0
    v_mfma_f32_16x16x32_bf16 v[64:67], v[148:151], v[212:215], v[64:67]
    v_mfma_f32_16x16x32_bf16 v[64:67], v[152:155], v[216:219], v[64:67]
    v_mfma_f32_16x16x32_bf16 v[64:67], v[156:159], v[220:223], v[64:67]
    v_mfma_f32_16x16x32_bf16 v[64:67], v[160:163], v[224:227], v[64:67]
    v_mfma_f32_16x16x32_bf16 v[64:67], v[164:167], v[228:231], v[64:67]
    v_mfma_f32_16x16x32_bf16 v[64:67], v[168:171], v[232:235], v[64:67]
    v_mfma_f32_16x16x32_bf16 v[64:67], v[172:175], v[236:239], v[64:67]
L_y4_67:
    s_nop 5
    v_permlane32_swap_b32 v56, v60
    v_permlane32_swap_b32 v57, v61
    v_permlane32_swap_b32 v58, v62
    v_permlane32_swap_b32 v59, v63
    v_add_f32_dpp v56, v60, v56 row_ror:8 row_mask:0xf bank_mask:0xf
    v_add_f32_dpp v57, v61, v57 row_ror:8 row_mask:0xf bank_mask:0xf
    v_add_f32_dpp v58, v62, v58 row_ror:8 row_mask:0xf bank_mask:0xf
    v_add_f32_dpp v59, v63, v59 row_ror:8 row_mask:0xf bank_mask:0xf
    v_bfi_b32 v56, v43, s60, v56
    v_bfi_b32 v57, v43, s61, v57
    v_bfi_b32 v58, v43, s62, v58
    v_bfi_b32 v59, v43, s63, v59
    s_mov_b32 exec_lo, 0x00ff00ff
    s_mov_b32 exec_hi, 0x00ff00ff
    buffer_store_dwordx4 v[56:59], v19, s[12:15], s76 offen sc1
    s_cmp_lg_u32 s77, 0
    s_cbranch_scc1 L_pt_70
    s_mov_b64 exec, -1
    v_mov_b32 v60, v64
    v_mov_b32 v61, v65
    v_mov_b32 v62, v66
    v_mov_b32 v63, v67
    v_permlane32_swap_b32 v64, v60
    v_permlane32_swap_b32 v65, v61
    v_permlane32_swap_b32 v66, v62
    v_permlane32_swap_b32 v67, v63
    v_add_f32_dpp v64, v60, v64 row_ror:8 row_mask:0xf bank_mask:0xf
    v_add_f32_dpp v65, v61, v65 row_ror:8 row_mask:0xf bank_mask:0xf
    v_add_f32_dpp v66, v62, v66 row_ror:8 row_mask:0xf bank_mask:0xf
    v_add_f32_dpp v67, v63, v67 row_ror:8 row_mask:0xf bank_mask:0xf
    v_bfi_b32 v64, v43, s60, v64
    v_bfi_b32 v65, v43, s61, v65
    v_bfi_b32 v66, v43, s62, v66
    v_bfi_b32 v67, v43, s63, v67
    s_mov_b32 exec_lo, 0x00ff00ff
    s_mov_b32 exec_hi, 0x00000000
    buffer_store_dwordx4 v[64:67], v19, s[12:15], s76 offen offset:2048 sc1
L_pt_70:
    s_mov_b64 exec, -1
L_Gend:
L_end:
    s_endpgm
L_code_end:
.section .rodata,"a"
.p2align 6
.amdhsa_kernel recurrent_scan__compressed_kv_cla__dense_activation_gelu__decode_kernel
  .amdhsa_next_free_vgpr 256
  .amdhsa_next_free_sgpr 102
  .amdhsa_accum_offset 256
  .amdhsa_group_segment_fixed_size 0
  .amdhsa_kernarg_size 112
  .amdhsa_user_sgpr_count 2
  .amdhsa_user_sgpr_kernarg_segment_ptr 1
  .amdhsa_system_sgpr_workgroup_id_x 1
.end_amdhsa_kernel
```
